```python
import torch

def _softmax(x, axis=-1):
    return torch.softmax(x, dim=axis)
def _gelu(x):
    return torch.nn.functional.gelu(x, approximate="tanh")
def _silu(x):
    return torch.nn.functional.silu(x)
def _sigmoid(x):
    return torch.sigmoid(x)
def _layernorm(x, axis=-1, eps=1e-5):
    m = x.mean(dim=axis, keepdim=True)
    v = x.var(dim=axis, keepdim=True, unbiased=False)
    return (x - m) / torch.sqrt(v + eps)
def _scatter_add(tgt, idx, src, axis=0):
    return tgt.clone().index_add_(axis, idx, src)
def _segment_sum(src, seg, n):
    out = torch.zeros((n,) + src.shape[1:], dtype=src.dtype)
    return out.index_add_(0, seg, src)
def _pad(x, pw):
    flat = tuple(v for pair in reversed(pw) for v in pair)
    return torch.nn.functional.pad(x, flat)

kernel_name = 'concat_heads__mha_block__spectral_fnet__prompt'

def setup_inputs():

    _w = (lambda a: (lambda t: t.to(torch.bfloat16) if t.is_floating_point() else t)(torch.as_tensor(a)))
    def _A_setup():
        B, S, D, H = 1, 2048, 512, 32
        return {
            "x": _w((lambda *s: torch.randn(*s, dtype=torch.bfloat16) * 0.2)(B, S, D)),
            "wqkv": _w((lambda *s: torch.randn(*s, dtype=torch.bfloat16) * 0.8)(D, 3 * D)),
            "wo": _w((lambda *s: torch.randn(*s, dtype=torch.bfloat16) * 0.2)(D, D)),
        }
    _A_in = _A_setup()

    def _B_setup():
        B, S, D = 1, 2048, 512
        ns = torch.arange(S)[:, None] * torch.arange(S)[None, :]
        nd = torch.arange(D)[:, None] * torch.arange(D)[None, :]
        Ws_re = torch.cos(-2.0 * torch.pi * ns / S).to(float)
        Ws_im = torch.sin(-2.0 * torch.pi * ns / S).to(float)
        Wd_re = torch.cos(-2.0 * torch.pi * nd / D).to(float)
        Wd_im = torch.sin(-2.0 * torch.pi * nd / D).to(float)
        return {
            "x": _w((lambda *s: torch.randn(*s, dtype=torch.bfloat16) * 0.05)(B, S, D)),
            "dft_seq_re": _w(Ws_re),
            "dft_seq_im": _w(Ws_im),
            "dft_hid_re": _w(Wd_re),
            "dft_hid_im": _w(Wd_im),
        }
    _B_in = _B_setup()

    return {
        "A_x": _A_in["x"],
        "A_wqkv": _A_in["wqkv"],
        "A_wo": _A_in["wo"],
        "B_x": _B_in["x"],
        "B_dft_seq_re": _B_in["dft_seq_re"],
        "B_dft_seq_im": _B_in["dft_seq_im"],
        "B_dft_hid_re": _B_in["dft_hid_re"],
        "B_dft_hid_im": _B_in["dft_hid_im"],
    }

def reference(A_x, A_wqkv, A_wo, B_x, B_dft_seq_re, B_dft_seq_im, B_dft_hid_re, B_dft_hid_im):
    def _A_ref(x, wqkv, wo):
        B, S, D = x.shape
        H = 32
        Dh = D // H
        qkv = (lambda x, *d: x.permute(*d))((x @ wqkv).reshape(B, S, 3, H, Dh), 2, 0, 3, 1, 4)
        q, k, v = qkv[0], qkv[1], qkv[2]
        scores = torch.einsum("bhqd,bhkd->bhqk", q, k) * (Dh ** -0.5)
        p = _softmax(scores, axis=-1)
        o = torch.einsum("bhqk,bhkd->bhqd", p, v)
        return (lambda x, *d: x.permute(*d))(o, 0, 2, 1, 3).reshape(B, S, D) @ wo

    def _B_ref(x, dft_seq_re, dft_seq_im, dft_hid_re, dft_hid_im):
        a = torch.einsum("bsd,ed->bse", x, dft_hid_re)
        b = torch.einsum("bsd,ed->bse", x, dft_hid_im)
        y = torch.einsum("ts,bse->bte", dft_seq_re, a) - torch.einsum("ts,bse->bte", dft_seq_im, b)
        return y

    a = _A_ref(A_x, A_wqkv, A_wo)
    b = _B_ref(B_x, B_dft_seq_re, B_dft_seq_im, B_dft_hid_re, B_dft_hid_im)
    return torch.concatenate([a, b], axis=-1)
```

```asm
; @launch grid=(256,1,1) block=(768,1,1) lds=163840
.amdgcn_target "amdgcn-amd-amdhsa--gfx950"
.text
.globl concat_heads__mha_block__spectral_fnet__prompt_kernel
.p2align 8
.type concat_heads__mha_block__spectral_fnet__prompt_kernel,@function
concat_heads__mha_block__spectral_fnet__prompt_kernel:
    s_cmp_ge_u32 s2, 256
    s_cbranch_scc1 L_exit
    s_load_dwordx16 s[4:19], s[0:1], 0
    s_load_dwordx4 s[20:23], s[0:1], 64
    s_load_dwordx2 s[24:25], s[0:1], 80
    v_lshrrev_b32 v1, 6, v0
    v_and_b32 v0, 63, v0
    v_readfirstlane_b32 s3, v1
    s_lshr_b32 s56, s2, 3
    s_and_b32 s57, s2, 7
    s_add_u32 s58, s56, s57
    s_lshl_b32 s57, s57, 2
    s_lshr_b32 s57, 0x26540713, s57
    s_and_b32 s57, s57, 7
    s_cmp_lt_u32 s3, 4
    s_cbranch_scc1 L_computeA
    s_sub_u32 s60, s3, 4
    v_lshrrev_b32 v5, 3, v0
    v_lshlrev_b32 v2, 10, v5
    v_mul_u32_u24 v3, 3072, v5
    v_and_b32 v5, 7, v0
    v_lshrrev_b32 v6, 4, v0
    s_and_b32 s61, s60, 1
    s_lshl_b32 s61, s61, 2
    v_xor_b32 v7, s61, v6
    v_xor_b32 v7, v7, v5
    v_lshl_add_u32 v2, v7, 4, v2
    v_and_b32 v6, 1, v6
    v_lshlrev_b32 v6, 2, v6
    v_xor_b32 v5, v5, v6
    v_lshl_add_u32 v3, v5, 4, v3
    s_lshl_b32 s62, s56, 16
    s_lshl_b32 s61, s60, 13
    s_add_u32 s62, s62, s61
    s_mul_i32 s63, s60, 24576
    s_lshl_b32 s61, s57, 7
    s_add_u32 s63, s63, s61
    s_lshl_b32 s64, s60, 10
    s_waitcnt lgkmcnt(0)
    s_mov_b32 s28, s4
    s_and_b32 s29, s5, 0xffff
    s_mov_b32 s30, 0x200000
    s_mov_b32 s31, 0x20000
    s_mov_b32 s32, s6
    s_and_b32 s33, s7, 0xffff
    s_mov_b32 s34, 0x180000
    s_mov_b32 s35, 0x20000
    s_mov_b32 s40, s22
    s_and_b32 s41, s23, 0xffff
    s_mov_b32 s42, 0x100
    s_mov_b32 s43, 0x20000
    s_lshl_b32 s61, s2, 4
    s_add_u32 s61, s61, s3
    s_cmp_lg_u32 s61, 8
    s_cbranch_scc1 L_nonce_src_1
    s_memrealtime s[68:69]
    v_mov_b32 v8, 0
    s_waitcnt lgkmcnt(0)
    s_or_b32 s68, s68, 1
    s_xor_b32 s69, s69, 0x5bd1e995
    v_mov_b32 v10, s68
    v_mov_b32 v11, s69
    s_mov_b64 exec, 1
    buffer_store_dwordx2 v[10:11], v8, s[40:43], 0 offen sc1
    s_mov_b64 exec, -1
L_nonce_src_1:
    s_add_u32 s65, s58, 0
    s_and_b32 s65, s65, 7
    s_lshl_b32 s66, s65, 7
    s_add_u32 s66, s66, s62
    s_add_u32 m0, s64, 0
    s_mul_i32 s67, s65, 196608
    buffer_load_dwordx4 v2, s[28:31], s66 offen lds
    s_add_u32 s67, s67, s63
    s_add_u32 m0, s64, 8192
    s_nop 0
    buffer_load_dwordx4 v3, s[32:35], s67 offen offset:0 lds
    s_add_u32 m0, s64, 15360
    s_nop 0
    buffer_load_dwordx4 v3, s[32:35], s67 offen offset:1024 lds
    s_add_u32 m0, s64, 22528
    s_nop 0
    buffer_load_dwordx4 v3, s[32:35], s67 offen offset:2048 lds
    s_add_u32 s65, s58, 1
    s_and_b32 s65, s65, 7
    s_lshl_b32 s66, s65, 7
    s_add_u32 s66, s66, s62
    s_add_u32 m0, s64, 32768
    s_mul_i32 s67, s65, 196608
    buffer_load_dwordx4 v2, s[28:31], s66 offen lds
    s_add_u32 s67, s67, s63
    s_add_u32 m0, s64, 40960
    s_nop 0
    buffer_load_dwordx4 v3, s[32:35], s67 offen offset:0 lds
    s_add_u32 m0, s64, 48128
    s_nop 0
    buffer_load_dwordx4 v3, s[32:35], s67 offen offset:1024 lds
    s_add_u32 m0, s64, 55296
    s_nop 0
    buffer_load_dwordx4 v3, s[32:35], s67 offen offset:2048 lds
    s_mov_b32 s36, s24
    s_and_b32 s37, s25, 0xffff
    s_mov_b32 s38, 0x10000000
    s_mov_b32 s39, 0x20000
    v_mov_b32 v14, 0
    s_cmp_ge_u32 s3, 8
    s_cbranch_scc1 L_hsetup
    s_and_b32 s92, s2, 3
    s_lshl_b32 s92, s92, 3
    s_bfe_u32 s94, s2, 0x30003
    s_add_u32 s92, s92, s94
    s_lshr_b32 s95, s2, 6
    s_bfe_u32 s91, s2, 0x10002
    s_lshl_b32 s91, s91, 2
    s_add_u32 s91, s91, s95
    s_lshl_b32 s93, s91, 1
    s_add_u32 s93, s93, s60
    s_add_u32 s94, s94, s95
    s_add_u32 s95, s94, s60
    s_and_b32 s95, s95, 3
    s_and_b32 s94, s94, 4
    s_add_u32 s94, s94, s95
    v_lshrrev_b32 v5, 3, v0
    v_lshlrev_b32 v4, 10, v5
    v_and_b32 v5, 7, v0
    v_lshrrev_b32 v6, 4, v0
    v_xor_b32 v5, v5, v6
    v_lshl_add_u32 v4, v5, 4, v4
    v_xor_b32 v5, 64, v4
    s_lshl_b32 s68, s92, 13
    v_add_u32 v8, s68, v4
    v_lshrrev_b32 v6, 3, v0
    s_lshl_b32 s68, s92, 3
    v_add_u32 v6, s68, v6
    v_cmp_eq_u32 vcc, 0, v6
    v_sub_u32 v6, 512, v6
    v_mov_b32 v7, 256
    v_and_b32 v9, 0x70, v5
    v_cndmask_b32 v6, v6, v7, vcc
    v_lshl_add_u32 v9, v6, 10, v9
    s_lshl_b32 s69, s91, 15
    s_mov_b32 s48, s10
    s_and_b32 s49, s11, 0xffff
    s_mov_b32 s50, 0x200000
    s_mov_b32 s51, 0x20000
    s_mov_b32 s44, s16
    s_and_b32 s45, s17, 0xffff
    s_mov_b32 s46, 0x80000
    s_mov_b32 s47, 0x20000
    s_mov_b32 s52, s18
    s_and_b32 s53, s19, 0xffff
    s_mov_b32 s54, 0x80000
    s_mov_b32 s55, 0x20000
    v_and_b32 v157, 1, v0
    v_mul_u32_u24 v157, 0x8000, v157
    v_lshl_or_b32 v157, v157, 16, v157
    s_bitcmp1_b32 s94, 2
    s_cselect_b32 s65, -1, 0
    v_and_b32 v156, s65, v157
    v_and_b32 v20, 15, v0
    v_lshrrev_b32 v21, 1, v20
    v_lshrrev_b32 v22, 4, v0
    v_xor_b32 v21, v21, v22
    v_lshlrev_b32 v21, 4, v21
    v_lshl_add_u32 v16, v20, 7, v21
    v_xor_b32 v17, 64, v16
    v_lshlrev_b32 v23, 4, v0
    v_mov_b32 v92, 0
    v_mov_b32 v93, 0
    v_mov_b32 v94, 0
    v_mov_b32 v95, 0
    v_mov_b32 v96, 0
    v_mov_b32 v97, 0
    v_mov_b32 v98, 0
    v_mov_b32 v99, 0
    v_mov_b32 v100, 0
    v_mov_b32 v101, 0
    v_mov_b32 v102, 0
    v_mov_b32 v103, 0
    v_mov_b32 v104, 0
    v_mov_b32 v105, 0
    v_mov_b32 v106, 0
    v_mov_b32 v107, 0
    v_mov_b32 v108, 0
    v_mov_b32 v109, 0
    v_mov_b32 v110, 0
    v_mov_b32 v111, 0
    v_mov_b32 v112, 0
    v_mov_b32 v113, 0
    v_mov_b32 v114, 0
    v_mov_b32 v115, 0
    v_mov_b32 v116, 0
    v_mov_b32 v117, 0
    v_mov_b32 v118, 0
    v_mov_b32 v119, 0
    v_mov_b32 v120, 0
    v_mov_b32 v121, 0
    v_mov_b32 v122, 0
    v_mov_b32 v123, 0
    v_mov_b32 v124, 0
    v_mov_b32 v125, 0
    v_mov_b32 v126, 0
    v_mov_b32 v127, 0
    v_mov_b32 v128, 0
    v_mov_b32 v129, 0
    v_mov_b32 v130, 0
    v_mov_b32 v131, 0
    v_mov_b32 v132, 0
    v_mov_b32 v133, 0
    v_mov_b32 v134, 0
    v_mov_b32 v135, 0
    v_mov_b32 v136, 0
    v_mov_b32 v137, 0
    v_mov_b32 v138, 0
    v_mov_b32 v139, 0
    v_mov_b32 v140, 0
    v_mov_b32 v141, 0
    v_mov_b32 v142, 0
    v_mov_b32 v143, 0
    v_mov_b32 v144, 0
    v_mov_b32 v145, 0
    v_mov_b32 v146, 0
    v_mov_b32 v147, 0
    v_mov_b32 v148, 0
    v_mov_b32 v149, 0
    v_mov_b32 v150, 0
    v_mov_b32 v151, 0
    v_mov_b32 v152, 0
    v_mov_b32 v153, 0
    v_mov_b32 v154, 0
    v_mov_b32 v155, 0
    v_mov_b32 v24, 0xbf803f80
    v_mov_b32 v25, 0xbf803f80
    v_mov_b32 v26, 0xbf803f80
    v_mov_b32 v27, 0xbf803f80
    s_branch L_common
L_hsetup:
    s_mov_b32 s44, s16
    s_and_b32 s45, s17, 0xffff
    s_mov_b32 s46, 0x80000
    s_mov_b32 s47, 0x20000
    v_mov_b32 v4, 0
    v_mov_b32 v5, 0
    v_mov_b32 v8, 0
    v_mov_b32 v9, 0
    s_lshl_b32 s72, s57, 2
    s_bfe_u32 s73, s2, 0x20003
    s_add_u32 s72, s72, s73
    s_lshr_b32 s73, s2, 5
    s_lshl_b32 s74, s72, 16
    s_sub_u32 s75, s3, 8
    v_lshlrev_b32 v16, 4, v0
    v_lshlrev_b32 v17, 3, v0
    s_mov_b32 s48, s20
    s_and_b32 s49, s21, 0xffff
    s_mov_b32 s50, 0x400000
    s_mov_b32 s51, 0x20000
    s_mov_b32 s52, s8
    s_and_b32 s53, s9, 0xffff
    s_mov_b32 s54, 0x80000
    s_mov_b32 s55, 0x20000
    s_lshr_b32 s76, s72, 1
    s_lshl_b32 s76, s76, 9
    s_add_u32 s82, s76, 22020096
    s_lshl_b32 s76, s75, 11
    s_mul_i32 s77, s75, 2112
    s_add_u32 s78, s74, s76
    s_lshl_b32 s79, s73, 13
    s_add_u32 s79, s79, s78
    s_add_u32 s80, s78, 2097152
    s_add_u32 s81, s78, 4194304
    v_lshlrev_b32 v18, 2, v0
    v_add_u32 v18, 143488, v18
    s_lshl_b32 s83, s75, 2
    s_add_u32 s83, s83, 143488
    v_mov_b32 v21, s83
    v_mov_b32 v32, 0x3f803f80
    v_mov_b32 v33, 0x3f803f80
    v_mov_b32 v34, 0x3f803f80
    v_mov_b32 v35, 0x3f803f80
    v_mov_b32 v36, 0
    v_mov_b32 v37, 0
    v_mov_b32 v38, 0
    v_mov_b32 v39, 0
    v_mul_u32_u24 v19, 1056, v0
    v_add_u32 v19, 66560, v19
L_common:
    s_waitcnt vmcnt(4)
    s_barrier
    s_add_u32 s65, s58, 2
    s_and_b32 s65, s65, 7
    s_lshl_b32 s66, s65, 7
    s_add_u32 s66, s66, s62
    s_add_u32 m0, s64, 65536
    s_mul_i32 s67, s65, 196608
    buffer_load_dwordx4 v2, s[28:31], s66 offen lds
    s_add_u32 s67, s67, s63
    s_add_u32 m0, s64, 73728
    s_nop 0
    buffer_load_dwordx4 v3, s[32:35], s67 offen offset:0 lds
    s_add_u32 m0, s64, 80896
    s_nop 0
    buffer_load_dwordx4 v3, s[32:35], s67 offen offset:1024 lds
    s_add_u32 m0, s64, 88064
    s_nop 0
    buffer_load_dwordx4 v3, s[32:35], s67 offen offset:2048 lds
    s_add_u32 s65, s58, 3
    s_and_b32 s65, s65, 7
    s_lshl_b32 s66, s65, 7
    s_add_u32 s66, s66, s62
    s_add_u32 m0, s64, 98304
    s_mul_i32 s67, s65, 196608
    buffer_load_dwordx4 v2, s[28:31], s66 offen lds
    s_add_u32 s67, s67, s63
    s_add_u32 m0, s64, 106496
    s_nop 0
    buffer_load_dwordx4 v3, s[32:35], s67 offen offset:0 lds
    s_add_u32 m0, s64, 113664
    s_nop 0
    buffer_load_dwordx4 v3, s[32:35], s67 offen offset:1024 lds
    s_add_u32 m0, s64, 120832
    s_nop 0
    buffer_load_dwordx4 v3, s[32:35], s67 offen offset:2048 lds
    s_waitcnt vmcnt(8)
    s_barrier
    s_add_u32 s65, s58, 4
    s_and_b32 s65, s65, 7
    s_lshl_b32 s66, s65, 7
    s_add_u32 s66, s66, s62
    s_add_u32 m0, s64, 131072
    s_mul_i32 s67, s65, 196608
    buffer_load_dwordx4 v2, s[28:31], s66 offen lds
    s_add_u32 s67, s67, s63
    s_add_u32 m0, s64, 139264
    s_nop 0
    buffer_load_dwordx4 v3, s[32:35], s67 offen offset:0 lds
    s_add_u32 m0, s64, 146432
    s_nop 0
    buffer_load_dwordx4 v3, s[32:35], s67 offen offset:1024 lds
    s_add_u32 m0, s64, 153600
    s_nop 0
    buffer_load_dwordx4 v3, s[32:35], s67 offen offset:2048 lds
    s_waitcnt vmcnt(8)
    s_barrier
    s_add_u32 s65, s58, 5
    s_and_b32 s65, s65, 7
    s_lshl_b32 s66, s65, 7
    s_add_u32 s66, s66, s62
    s_add_u32 m0, s64, 0
    s_mul_i32 s67, s65, 196608
    buffer_load_dwordx4 v2, s[28:31], s66 offen lds
    s_add_u32 s67, s67, s63
    s_add_u32 m0, s64, 8192
    s_nop 0
    buffer_load_dwordx4 v3, s[32:35], s67 offen offset:0 lds
    s_add_u32 m0, s64, 15360
    s_nop 0
    buffer_load_dwordx4 v3, s[32:35], s67 offen offset:1024 lds
    s_add_u32 m0, s64, 22528
    s_nop 0
    buffer_load_dwordx4 v3, s[32:35], s67 offen offset:2048 lds
    s_waitcnt vmcnt(8)
    s_barrier
    s_add_u32 s65, s58, 6
    s_and_b32 s65, s65, 7
    s_lshl_b32 s66, s65, 7
    s_add_u32 s66, s66, s62
    s_add_u32 m0, s64, 32768
    s_mul_i32 s67, s65, 196608
    buffer_load_dwordx4 v2, s[28:31], s66 offen lds
    s_add_u32 s67, s67, s63
    s_add_u32 m0, s64, 40960
    s_nop 0
    buffer_load_dwordx4 v3, s[32:35], s67 offen offset:0 lds
    s_add_u32 m0, s64, 48128
    s_nop 0
    buffer_load_dwordx4 v3, s[32:35], s67 offen offset:1024 lds
    s_add_u32 m0, s64, 55296
    s_nop 0
    buffer_load_dwordx4 v3, s[32:35], s67 offen offset:2048 lds
    s_waitcnt vmcnt(8)
    s_barrier
    s_add_u32 s65, s58, 7
    s_and_b32 s65, s65, 7
    s_lshl_b32 s66, s65, 7
    s_add_u32 s66, s66, s62
    s_add_u32 m0, s64, 65536
    s_mul_i32 s67, s65, 196608
    buffer_load_dwordx4 v2, s[28:31], s66 offen lds
    s_add_u32 s67, s67, s63
    s_add_u32 m0, s64, 73728
    s_nop 0
    buffer_load_dwordx4 v3, s[32:35], s67 offen offset:0 lds
    s_add_u32 m0, s64, 80896
    s_nop 0
    buffer_load_dwordx4 v3, s[32:35], s67 offen offset:1024 lds
    s_add_u32 m0, s64, 88064
    s_nop 0
    buffer_load_dwordx4 v3, s[32:35], s67 offen offset:2048 lds
    buffer_load_dwordx2 v[12:13], v14, s[40:43], 0 offen sc1
    s_cmp_ge_u32 s3, 8
    s_cbranch_scc1 L_helper
    s_cmp_eq_u32 s60, 1
    s_cbranch_scc1 L_b_w_3
    s_cmp_eq_u32 s60, 2
    s_cbranch_scc1 L_b_w_4
    s_cmp_eq_u32 s60, 3
    s_cbranch_scc1 L_b_w_5
L_b_w_2:
    s_mov_b32 s72, 98304
    s_mov_b32 s73, 32768
    s_xor_b32 s65, s94, 0
    s_lshl_b32 s66, s65, 7
    s_lshl_b32 s65, s95, 7
    s_add_u32 s65, s65, s69
    s_mov_b32 m0, 106496
    s_add_u32 s67, s65, 0
    buffer_load_dwordx4 v4, s[44:47], s67 offen lds
    s_mov_b32 m0, 107520
    s_add_u32 s67, s65, 8192
    buffer_load_dwordx4 v5, s[44:47], s67 offen lds
    s_mov_b32 m0, 108544
    s_add_u32 s67, s65, 0
    buffer_load_dwordx4 v4, s[52:55], s67 offen lds
    s_mov_b32 m0, 109568
    s_add_u32 s67, s65, 8192
    buffer_load_dwordx4 v5, s[52:55], s67 offen lds
    s_mov_b32 m0, 110592
    s_add_u32 s67, s65, 16384
    buffer_load_dwordx4 v4, s[44:47], s67 offen lds
    s_mov_b32 m0, 111616
    s_add_u32 s67, s65, 24576
    buffer_load_dwordx4 v5, s[44:47], s67 offen lds
    s_mov_b32 m0, 112640
    s_add_u32 s67, s65, 16384
    buffer_load_dwordx4 v4, s[52:55], s67 offen lds
    s_mov_b32 m0, 113664
    s_add_u32 s67, s65, 24576
    buffer_load_dwordx4 v5, s[52:55], s67 offen lds
    s_waitcnt vmcnt(17)
    s_barrier
    s_xor_b32 s65, s94, 0
    s_lshl_b32 s66, s65, 7
    s_lshl_b32 s65, s95, 7
    s_add_u32 s65, s65, s69
    s_mov_b32 m0, 98304
    s_add_u32 s67, s66, 0
    buffer_load_dwordx4 v8, s[48:51], s67 offen lds
    s_mov_b32 m0, 99328
    s_add_u32 s67, s66, 0
    buffer_load_dwordx4 v9, s[48:51], s67 offen lds
    s_mov_b32 m0, 100352
    s_add_u32 s67, s66, 524288
    buffer_load_dwordx4 v8, s[48:51], s67 offen lds
    s_mov_b32 m0, 101376
    s_add_u32 s67, s66, 524288
    buffer_load_dwordx4 v9, s[48:51], s67 offen lds
    s_mov_b32 m0, 102400
    s_add_u32 s67, s66, 1048576
    buffer_load_dwordx4 v8, s[48:51], s67 offen lds
    s_mov_b32 m0, 103424
    s_add_u32 s67, s66, 1048576
    buffer_load_dwordx4 v9, s[48:51], s67 offen lds
    s_mov_b32 m0, 104448
    s_add_u32 s67, s66, 1572864
    buffer_load_dwordx4 v8, s[48:51], s67 offen lds
    s_mov_b32 m0, 105472
    s_add_u32 s67, s66, 1572864
    buffer_load_dwordx4 v9, s[48:51], s67 offen lds
    s_waitcnt vmcnt(21)
    s_barrier
    s_waitcnt vmcnt(17)
    s_barrier
    s_xor_b32 s65, s94, 4
    s_lshl_b32 s66, s65, 7
    s_lshl_b32 s65, s95, 7
    s_add_u32 s65, s65, s69
    s_mov_b32 m0, 32768
    s_add_u32 s67, s66, 0
    buffer_load_dwordx4 v8, s[48:51], s67 offen lds
    s_mov_b32 m0, 33792
    s_add_u32 s67, s66, 0
    buffer_load_dwordx4 v9, s[48:51], s67 offen lds
    s_mov_b32 m0, 34816
    s_add_u32 s67, s66, 524288
    buffer_load_dwordx4 v8, s[48:51], s67 offen lds
    s_mov_b32 m0, 35840
    s_add_u32 s67, s66, 524288
    buffer_load_dwordx4 v9, s[48:51], s67 offen lds
    s_mov_b32 m0, 36864
    s_add_u32 s67, s66, 1048576
    buffer_load_dwordx4 v8, s[48:51], s67 offen lds
    s_mov_b32 m0, 37888
    s_add_u32 s67, s66, 1048576
    buffer_load_dwordx4 v9, s[48:51], s67 offen lds
    s_mov_b32 m0, 38912
    s_add_u32 s67, s66, 1572864
    buffer_load_dwordx4 v8, s[48:51], s67 offen lds
    s_mov_b32 m0, 39936
    s_add_u32 s67, s66, 1572864
    buffer_load_dwordx4 v9, s[48:51], s67 offen lds
    s_branch L_b_common_6
L_b_w_3:
    s_mov_b32 s72, 114688
    s_mov_b32 s73, 40960
    s_xor_b32 s65, s94, 0
    s_lshl_b32 s66, s65, 7
    s_lshl_b32 s65, s95, 7
    s_add_u32 s65, s65, s69
    s_mov_b32 m0, 122880
    s_add_u32 s67, s65, 0
    buffer_load_dwordx4 v4, s[44:47], s67 offen lds
    s_mov_b32 m0, 123904
    s_add_u32 s67, s65, 8192
    buffer_load_dwordx4 v5, s[44:47], s67 offen lds
    s_mov_b32 m0, 124928
    s_add_u32 s67, s65, 0
    buffer_load_dwordx4 v4, s[52:55], s67 offen lds
    s_mov_b32 m0, 125952
    s_add_u32 s67, s65, 8192
    buffer_load_dwordx4 v5, s[52:55], s67 offen lds
    s_mov_b32 m0, 126976
    s_add_u32 s67, s65, 16384
    buffer_load_dwordx4 v4, s[44:47], s67 offen lds
    s_mov_b32 m0, 128000
    s_add_u32 s67, s65, 24576
    buffer_load_dwordx4 v5, s[44:47], s67 offen lds
    s_mov_b32 m0, 129024
    s_add_u32 s67, s65, 16384
    buffer_load_dwordx4 v4, s[52:55], s67 offen lds
    s_mov_b32 m0, 130048
    s_add_u32 s67, s65, 24576
    buffer_load_dwordx4 v5, s[52:55], s67 offen lds
    s_waitcnt vmcnt(17)
    s_barrier
    s_xor_b32 s65, s94, 0
    s_lshl_b32 s66, s65, 7
    s_lshl_b32 s65, s95, 7
    s_add_u32 s65, s65, s69
    s_mov_b32 m0, 114688
    s_add_u32 s67, s66, 0
    buffer_load_dwordx4 v8, s[48:51], s67 offen lds
    s_mov_b32 m0, 115712
    s_add_u32 s67, s66, 0
    buffer_load_dwordx4 v9, s[48:51], s67 offen lds
    s_mov_b32 m0, 116736
    s_add_u32 s67, s66, 524288
    buffer_load_dwordx4 v8, s[48:51], s67 offen lds
    s_mov_b32 m0, 117760
    s_add_u32 s67, s66, 524288
    buffer_load_dwordx4 v9, s[48:51], s67 offen lds
    s_mov_b32 m0, 118784
    s_add_u32 s67, s66, 1048576
    buffer_load_dwordx4 v8, s[48:51], s67 offen lds
    s_mov_b32 m0, 119808
    s_add_u32 s67, s66, 1048576
    buffer_load_dwordx4 v9, s[48:51], s67 offen lds
    s_mov_b32 m0, 120832
    s_add_u32 s67, s66, 1572864
    buffer_load_dwordx4 v8, s[48:51], s67 offen lds
    s_mov_b32 m0, 121856
    s_add_u32 s67, s66, 1572864
    buffer_load_dwordx4 v9, s[48:51], s67 offen lds
    s_waitcnt vmcnt(21)
    s_barrier
    s_waitcnt vmcnt(17)
    s_barrier
    s_xor_b32 s65, s94, 4
    s_lshl_b32 s66, s65, 7
    s_lshl_b32 s65, s95, 7
    s_add_u32 s65, s65, s69
    s_mov_b32 m0, 40960
    s_add_u32 s67, s66, 0
    buffer_load_dwordx4 v8, s[48:51], s67 offen lds
    s_mov_b32 m0, 41984
    s_add_u32 s67, s66, 0
    buffer_load_dwordx4 v9, s[48:51], s67 offen lds
    s_mov_b32 m0, 43008
    s_add_u32 s67, s66, 524288
    buffer_load_dwordx4 v8, s[48:51], s67 offen lds
    s_mov_b32 m0, 44032
    s_add_u32 s67, s66, 524288
    buffer_load_dwordx4 v9, s[48:51], s67 offen lds
    s_mov_b32 m0, 45056
    s_add_u32 s67, s66, 1048576
    buffer_load_dwordx4 v8, s[48:51], s67 offen lds
    s_mov_b32 m0, 46080
    s_add_u32 s67, s66, 1048576
    buffer_load_dwordx4 v9, s[48:51], s67 offen lds
    s_mov_b32 m0, 47104
    s_add_u32 s67, s66, 1572864
    buffer_load_dwordx4 v8, s[48:51], s67 offen lds
    s_mov_b32 m0, 48128
    s_add_u32 s67, s66, 1572864
    buffer_load_dwordx4 v9, s[48:51], s67 offen lds
    s_branch L_b_common_6
L_b_w_4:
    s_mov_b32 s72, 147456
    s_mov_b32 s73, 49152
    s_waitcnt vmcnt(9)
    s_barrier
    s_xor_b32 s65, s94, 0
    s_lshl_b32 s66, s65, 7
    s_lshl_b32 s65, s95, 7
    s_add_u32 s65, s65, s69
    s_mov_b32 m0, 155648
    s_add_u32 s67, s65, 0
    buffer_load_dwordx4 v4, s[44:47], s67 offen lds
    s_mov_b32 m0, 156672
    s_add_u32 s67, s65, 8192
    buffer_load_dwordx4 v5, s[44:47], s67 offen lds
    s_mov_b32 m0, 157696
    s_add_u32 s67, s65, 0
    buffer_load_dwordx4 v4, s[52:55], s67 offen lds
    s_mov_b32 m0, 158720
    s_add_u32 s67, s65, 8192
    buffer_load_dwordx4 v5, s[52:55], s67 offen lds
    s_mov_b32 m0, 159744
    s_add_u32 s67, s65, 16384
    buffer_load_dwordx4 v4, s[44:47], s67 offen lds
    s_mov_b32 m0, 160768
    s_add_u32 s67, s65, 24576
    buffer_load_dwordx4 v5, s[44:47], s67 offen lds
    s_mov_b32 m0, 161792
    s_add_u32 s67, s65, 16384
    buffer_load_dwordx4 v4, s[52:55], s67 offen lds
    s_mov_b32 m0, 162816
    s_add_u32 s67, s65, 24576
    buffer_load_dwordx4 v5, s[52:55], s67 offen lds
    s_waitcnt vmcnt(13)
    s_barrier
    s_xor_b32 s65, s94, 0
    s_lshl_b32 s66, s65, 7
    s_lshl_b32 s65, s95, 7
    s_add_u32 s65, s65, s69
    s_mov_b32 m0, 147456
    s_add_u32 s67, s66, 0
    buffer_load_dwordx4 v8, s[48:51], s67 offen lds
    s_mov_b32 m0, 148480
    s_add_u32 s67, s66, 0
    buffer_load_dwordx4 v9, s[48:51], s67 offen lds
    s_mov_b32 m0, 149504
    s_add_u32 s67, s66, 524288
    buffer_load_dwordx4 v8, s[48:51], s67 offen lds
    s_mov_b32 m0, 150528
    s_add_u32 s67, s66, 524288
    buffer_load_dwordx4 v9, s[48:51], s67 offen lds
    s_mov_b32 m0, 151552
    s_add_u32 s67, s66, 1048576
    buffer_load_dwordx4 v8, s[48:51], s67 offen lds
    s_mov_b32 m0, 152576
    s_add_u32 s67, s66, 1048576
    buffer_load_dwordx4 v9, s[48:51], s67 offen lds
    s_mov_b32 m0, 153600
    s_add_u32 s67, s66, 1572864
    buffer_load_dwordx4 v8, s[48:51], s67 offen lds
    s_mov_b32 m0, 154624
    s_add_u32 s67, s66, 1572864
    buffer_load_dwordx4 v9, s[48:51], s67 offen lds
    s_waitcnt vmcnt(17)
    s_barrier
    s_xor_b32 s65, s94, 4
    s_lshl_b32 s66, s65, 7
    s_lshl_b32 s65, s95, 7
    s_add_u32 s65, s65, s69
    s_mov_b32 m0, 49152
    s_add_u32 s67, s66, 0
    buffer_load_dwordx4 v8, s[48:51], s67 offen lds
    s_mov_b32 m0, 50176
    s_add_u32 s67, s66, 0
    buffer_load_dwordx4 v9, s[48:51], s67 offen lds
    s_mov_b32 m0, 51200
    s_add_u32 s67, s66, 524288
    buffer_load_dwordx4 v8, s[48:51], s67 offen lds
    s_mov_b32 m0, 52224
    s_add_u32 s67, s66, 524288
    buffer_load_dwordx4 v9, s[48:51], s67 offen lds
    s_mov_b32 m0, 53248
    s_add_u32 s67, s66, 1048576
    buffer_load_dwordx4 v8, s[48:51], s67 offen lds
    s_mov_b32 m0, 54272
    s_add_u32 s67, s66, 1048576
    buffer_load_dwordx4 v9, s[48:51], s67 offen lds
    s_mov_b32 m0, 55296
    s_add_u32 s67, s66, 1572864
    buffer_load_dwordx4 v8, s[48:51], s67 offen lds
    s_mov_b32 m0, 56320
    s_add_u32 s67, s66, 1572864
    buffer_load_dwordx4 v9, s[48:51], s67 offen lds
    s_branch L_b_common_6
L_b_w_5:
    s_mov_b32 s72, 16384
    s_mov_b32 s73, 57344
    s_waitcnt vmcnt(9)
    s_barrier
    s_waitcnt vmcnt(5)
    s_barrier
    s_xor_b32 s65, s94, 0
    s_lshl_b32 s66, s65, 7
    s_lshl_b32 s65, s95, 7
    s_add_u32 s65, s65, s69
    s_mov_b32 m0, 24576
    s_add_u32 s67, s65, 0
    buffer_load_dwordx4 v4, s[44:47], s67 offen lds
    s_mov_b32 m0, 25600
    s_add_u32 s67, s65, 8192
    buffer_load_dwordx4 v5, s[44:47], s67 offen lds
    s_mov_b32 m0, 26624
    s_add_u32 s67, s65, 0
    buffer_load_dwordx4 v4, s[52:55], s67 offen lds
    s_mov_b32 m0, 27648
    s_add_u32 s67, s65, 8192
    buffer_load_dwordx4 v5, s[52:55], s67 offen lds
    s_mov_b32 m0, 28672
    s_add_u32 s67, s65, 16384
    buffer_load_dwordx4 v4, s[44:47], s67 offen lds
    s_mov_b32 m0, 29696
    s_add_u32 s67, s65, 24576
    buffer_load_dwordx4 v5, s[44:47], s67 offen lds
    s_mov_b32 m0, 30720
    s_add_u32 s67, s65, 16384
    buffer_load_dwordx4 v4, s[52:55], s67 offen lds
    s_mov_b32 m0, 31744
    s_add_u32 s67, s65, 24576
    buffer_load_dwordx4 v5, s[52:55], s67 offen lds
    s_waitcnt vmcnt(9)
    s_barrier
    s_xor_b32 s65, s94, 0
    s_lshl_b32 s66, s65, 7
    s_lshl_b32 s65, s95, 7
    s_add_u32 s65, s65, s69
    s_mov_b32 m0, 16384
    s_add_u32 s67, s66, 0
    buffer_load_dwordx4 v8, s[48:51], s67 offen lds
    s_mov_b32 m0, 17408
    s_add_u32 s67, s66, 0
    buffer_load_dwordx4 v9, s[48:51], s67 offen lds
    s_mov_b32 m0, 18432
    s_add_u32 s67, s66, 524288
    buffer_load_dwordx4 v8, s[48:51], s67 offen lds
    s_mov_b32 m0, 19456
    s_add_u32 s67, s66, 524288
    buffer_load_dwordx4 v9, s[48:51], s67 offen lds
    s_mov_b32 m0, 20480
    s_add_u32 s67, s66, 1048576
    buffer_load_dwordx4 v8, s[48:51], s67 offen lds
    s_mov_b32 m0, 21504
    s_add_u32 s67, s66, 1048576
    buffer_load_dwordx4 v9, s[48:51], s67 offen lds
    s_mov_b32 m0, 22528
    s_add_u32 s67, s66, 1572864
    buffer_load_dwordx4 v8, s[48:51], s67 offen lds
    s_mov_b32 m0, 23552
    s_add_u32 s67, s66, 1572864
    buffer_load_dwordx4 v9, s[48:51], s67 offen lds
    s_xor_b32 s65, s94, 4
    s_lshl_b32 s66, s65, 7
    s_lshl_b32 s65, s95, 7
    s_add_u32 s65, s65, s69
    s_mov_b32 m0, 57344
    s_add_u32 s67, s66, 0
    buffer_load_dwordx4 v8, s[48:51], s67 offen lds
    s_mov_b32 m0, 58368
    s_add_u32 s67, s66, 0
    buffer_load_dwordx4 v9, s[48:51], s67 offen lds
    s_mov_b32 m0, 59392
    s_add_u32 s67, s66, 524288
    buffer_load_dwordx4 v8, s[48:51], s67 offen lds
    s_mov_b32 m0, 60416
    s_add_u32 s67, s66, 524288
    buffer_load_dwordx4 v9, s[48:51], s67 offen lds
    s_mov_b32 m0, 61440
    s_add_u32 s67, s66, 1048576
    buffer_load_dwordx4 v8, s[48:51], s67 offen lds
    s_mov_b32 m0, 62464
    s_add_u32 s67, s66, 1048576
    buffer_load_dwordx4 v9, s[48:51], s67 offen lds
    s_mov_b32 m0, 63488
    s_add_u32 s67, s66, 1572864
    buffer_load_dwordx4 v8, s[48:51], s67 offen lds
    s_mov_b32 m0, 64512
    s_add_u32 s67, s66, 1572864
    buffer_load_dwordx4 v9, s[48:51], s67 offen lds
L_b_common_6:
    s_setprio 0
    s_waitcnt vmcnt(8)
    v_add_u32 v18, s72, v16
    v_add_u32 v19, s72, v17
    s_cmp_lg_u32 s91, 0
    s_cbranch_scc1 L_b_patch_7
    v_add_u32 v20, s72, v23
    s_mov_b64 exec, 0xff
    ds_write_b128 v20, v[24:27] offset:10240
    s_mov_b64 exec, -1
L_b_patch_7:
    ds_read_b128 v[44:47], v18 offset:8192
    ds_read_b128 v[48:51], v18 offset:10240
    ds_read_b128 v[52:55], v18 offset:12288
    ds_read_b128 v[56:59], v18 offset:14336
    ds_read_b128 v[28:31], v18 offset:0
    ds_read_b128 v[32:35], v18 offset:2048
    ds_read_b128 v[36:39], v18 offset:4096
    ds_read_b128 v[40:43], v18 offset:6144
    ds_read_b128 v[76:79], v19 offset:8192
    ds_read_b128 v[80:83], v19 offset:10240
    ds_read_b128 v[84:87], v19 offset:12288
    ds_read_b128 v[88:91], v19 offset:14336
    ds_read_b128 v[60:63], v19 offset:0
    ds_read_b128 v[64:67], v19 offset:2048
    ds_read_b128 v[68:71], v19 offset:4096
    ds_read_b128 v[72:75], v19 offset:6144
    s_waitcnt lgkmcnt(12)
    v_xor_b32 v44, v156, v44
    v_xor_b32 v45, v156, v45
    v_xor_b32 v46, v156, v46
    v_xor_b32 v47, v156, v47
    v_xor_b32 v48, v156, v48
    v_xor_b32 v49, v156, v49
    v_xor_b32 v50, v156, v50
    v_xor_b32 v51, v156, v51
    v_xor_b32 v52, v156, v52
    v_xor_b32 v53, v156, v53
    v_xor_b32 v54, v156, v54
    v_xor_b32 v55, v156, v55
    v_xor_b32 v56, v156, v56
    v_xor_b32 v57, v156, v57
    v_xor_b32 v58, v156, v58
    v_xor_b32 v59, v156, v59
    s_waitcnt lgkmcnt(11)
    s_nop 0
    v_mfma_f32_16x16x32_bf16 v[92:95], v[28:31], v[44:47], v[92:95]
    v_mfma_f32_16x16x32_bf16 v[96:99], v[28:31], v[48:51], v[96:99]
    v_mfma_f32_16x16x32_bf16 v[124:127], v[28:31], v[52:55], v[124:127]
    v_mfma_f32_16x16x32_bf16 v[128:131], v[28:31], v[56:59], v[128:131]
    s_waitcnt lgkmcnt(10)
    v_mfma_f32_16x16x32_bf16 v[100:103], v[32:35], v[44:47], v[100:103]
    v_mfma_f32_16x16x32_bf16 v[104:107], v[32:35], v[48:51], v[104:107]
    v_mfma_f32_16x16x32_bf16 v[132:135], v[32:35], v[52:55], v[132:135]
    v_mfma_f32_16x16x32_bf16 v[136:139], v[32:35], v[56:59], v[136:139]
    s_waitcnt lgkmcnt(9)
    v_mfma_f32_16x16x32_bf16 v[108:111], v[36:39], v[44:47], v[108:111]
    v_mfma_f32_16x16x32_bf16 v[112:115], v[36:39], v[48:51], v[112:115]
    v_mfma_f32_16x16x32_bf16 v[140:143], v[36:39], v[52:55], v[140:143]
    v_mfma_f32_16x16x32_bf16 v[144:147], v[36:39], v[56:59], v[144:147]
    s_waitcnt lgkmcnt(8)
    v_mfma_f32_16x16x32_bf16 v[116:119], v[40:43], v[44:47], v[116:119]
    v_mfma_f32_16x16x32_bf16 v[120:123], v[40:43], v[48:51], v[120:123]
    v_mfma_f32_16x16x32_bf16 v[148:151], v[40:43], v[52:55], v[148:151]
    v_mfma_f32_16x16x32_bf16 v[152:155], v[40:43], v[56:59], v[152:155]
    s_waitcnt lgkmcnt(0)
    v_xor_b32 v76, v156, v76
    v_xor_b32 v77, v156, v77
    v_xor_b32 v78, v156, v78
    v_xor_b32 v79, v156, v79
    v_xor_b32 v80, v156, v80
    v_xor_b32 v81, v156, v81
    v_xor_b32 v82, v156, v82
    v_xor_b32 v83, v156, v83
    v_xor_b32 v84, v156, v84
    v_xor_b32 v85, v156, v85
    v_xor_b32 v86, v156, v86
    v_xor_b32 v87, v156, v87
    v_xor_b32 v88, v156, v88
    v_xor_b32 v89, v156, v89
    v_xor_b32 v90, v156, v90
    v_xor_b32 v91, v156, v91
    s_nop 1
    v_mfma_f32_16x16x32_bf16 v[92:95], v[60:63], v[76:79], v[92:95]
    v_mfma_f32_16x16x32_bf16 v[96:99], v[60:63], v[80:83], v[96:99]
    v_mfma_f32_16x16x32_bf16 v[124:127], v[60:63], v[84:87], v[124:127]
    v_mfma_f32_16x16x32_bf16 v[128:131], v[60:63], v[88:91], v[128:131]
    v_mfma_f32_16x16x32_bf16 v[100:103], v[64:67], v[76:79], v[100:103]
    v_mfma_f32_16x16x32_bf16 v[104:107], v[64:67], v[80:83], v[104:107]
    v_mfma_f32_16x16x32_bf16 v[132:135], v[64:67], v[84:87], v[132:135]
    v_mfma_f32_16x16x32_bf16 v[136:139], v[64:67], v[88:91], v[136:139]
    v_mfma_f32_16x16x32_bf16 v[108:111], v[68:71], v[76:79], v[108:111]
    v_mfma_f32_16x16x32_bf16 v[112:115], v[68:71], v[80:83], v[112:115]
    v_mfma_f32_16x16x32_bf16 v[140:143], v[68:71], v[84:87], v[140:143]
    v_mfma_f32_16x16x32_bf16 v[144:147], v[68:71], v[88:91], v[144:147]
    v_mfma_f32_16x16x32_bf16 v[116:119], v[72:75], v[76:79], v[116:119]
    v_mfma_f32_16x16x32_bf16 v[120:123], v[72:75], v[80:83], v[120:123]
    v_mfma_f32_16x16x32_bf16 v[148:151], v[72:75], v[84:87], v[148:151]
    v_mfma_f32_16x16x32_bf16 v[152:155], v[72:75], v[88:91], v[152:155]
    s_waitcnt vmcnt(0)
    v_add_u32 v18, s73, v16
    v_add_u32 v19, s73, v17
    ds_read_b128 v[28:31], v18 offset:0
    ds_read_b128 v[32:35], v18 offset:2048
    ds_read_b128 v[36:39], v18 offset:4096
    ds_read_b128 v[40:43], v18 offset:6144
    ds_read_b128 v[60:63], v19 offset:0
    ds_read_b128 v[64:67], v19 offset:2048
    ds_read_b128 v[68:71], v19 offset:4096
    ds_read_b128 v[72:75], v19 offset:6144
    v_xor_b32 v44, v157, v44
    v_xor_b32 v45, v157, v45
    v_xor_b32 v46, v157, v46
    v_xor_b32 v47, v157, v47
    v_xor_b32 v48, v157, v48
    v_xor_b32 v49, v157, v49
    v_xor_b32 v50, v157, v50
    v_xor_b32 v51, v157, v51
    v_xor_b32 v52, v157, v52
    v_xor_b32 v53, v157, v53
    v_xor_b32 v54, v157, v54
    v_xor_b32 v55, v157, v55
    v_xor_b32 v56, v157, v56
    v_xor_b32 v57, v157, v57
    v_xor_b32 v58, v157, v58
    v_xor_b32 v59, v157, v59
    v_xor_b32 v76, v157, v76
    v_xor_b32 v77, v157, v77
    v_xor_b32 v78, v157, v78
    v_xor_b32 v79, v157, v79
    v_xor_b32 v80, v157, v80
    v_xor_b32 v81, v157, v81
    v_xor_b32 v82, v157, v82
    v_xor_b32 v83, v157, v83
    v_xor_b32 v84, v157, v84
    v_xor_b32 v85, v157, v85
    v_xor_b32 v86, v157, v86
    v_xor_b32 v87, v157, v87
    v_xor_b32 v88, v157, v88
    v_xor_b32 v89, v157, v89
    v_xor_b32 v90, v157, v90
    v_xor_b32 v91, v157, v91
    s_waitcnt lgkmcnt(7)
    s_nop 0
    v_mfma_f32_16x16x32_bf16 v[92:95], v[28:31], v[44:47], v[92:95]
    v_mfma_f32_16x16x32_bf16 v[96:99], v[28:31], v[48:51], v[96:99]
    v_mfma_f32_16x16x32_bf16 v[124:127], v[28:31], v[52:55], v[124:127]
    v_mfma_f32_16x16x32_bf16 v[128:131], v[28:31], v[56:59], v[128:131]
    s_waitcnt lgkmcnt(6)
    v_mfma_f32_16x16x32_bf16 v[100:103], v[32:35], v[44:47], v[100:103]
    v_mfma_f32_16x16x32_bf16 v[104:107], v[32:35], v[48:51], v[104:107]
    v_mfma_f32_16x16x32_bf16 v[132:135], v[32:35], v[52:55], v[132:135]
    v_mfma_f32_16x16x32_bf16 v[136:139], v[32:35], v[56:59], v[136:139]
    s_waitcnt lgkmcnt(5)
    v_mfma_f32_16x16x32_bf16 v[108:111], v[36:39], v[44:47], v[108:111]
    v_mfma_f32_16x16x32_bf16 v[112:115], v[36:39], v[48:51], v[112:115]
    v_mfma_f32_16x16x32_bf16 v[140:143], v[36:39], v[52:55], v[140:143]
    v_mfma_f32_16x16x32_bf16 v[144:147], v[36:39], v[56:59], v[144:147]
    s_waitcnt lgkmcnt(4)
    v_mfma_f32_16x16x32_bf16 v[116:119], v[40:43], v[44:47], v[116:119]
    v_mfma_f32_16x16x32_bf16 v[120:123], v[40:43], v[48:51], v[120:123]
    v_mfma_f32_16x16x32_bf16 v[148:151], v[40:43], v[52:55], v[148:151]
    v_mfma_f32_16x16x32_bf16 v[152:155], v[40:43], v[56:59], v[152:155]
    s_waitcnt lgkmcnt(3)
    v_mfma_f32_16x16x32_bf16 v[92:95], v[60:63], v[76:79], v[92:95]
    v_mfma_f32_16x16x32_bf16 v[96:99], v[60:63], v[80:83], v[96:99]
    v_mfma_f32_16x16x32_bf16 v[124:127], v[60:63], v[84:87], v[124:127]
    v_mfma_f32_16x16x32_bf16 v[128:131], v[60:63], v[88:91], v[128:131]
    s_waitcnt lgkmcnt(2)
    v_mfma_f32_16x16x32_bf16 v[100:103], v[64:67], v[76:79], v[100:103]
    v_mfma_f32_16x16x32_bf16 v[104:107], v[64:67], v[80:83], v[104:107]
    v_mfma_f32_16x16x32_bf16 v[132:135], v[64:67], v[84:87], v[132:135]
    v_mfma_f32_16x16x32_bf16 v[136:139], v[64:67], v[88:91], v[136:139]
    s_waitcnt lgkmcnt(1)
    v_mfma_f32_16x16x32_bf16 v[108:111], v[68:71], v[76:79], v[108:111]
    v_mfma_f32_16x16x32_bf16 v[112:115], v[68:71], v[80:83], v[112:115]
    v_mfma_f32_16x16x32_bf16 v[140:143], v[68:71], v[84:87], v[140:143]
    v_mfma_f32_16x16x32_bf16 v[144:147], v[68:71], v[88:91], v[144:147]
    s_waitcnt lgkmcnt(0)
    v_mfma_f32_16x16x32_bf16 v[116:119], v[72:75], v[76:79], v[116:119]
    v_mfma_f32_16x16x32_bf16 v[120:123], v[72:75], v[80:83], v[120:123]
    v_mfma_f32_16x16x32_bf16 v[148:151], v[72:75], v[84:87], v[148:151]
    v_mfma_f32_16x16x32_bf16 v[152:155], v[72:75], v[88:91], v[152:155]
    s_setprio 3
    v_add_u32 v20, s72, v23
    s_lshl_b32 s65, s60, 2
    s_add_u32 s65, s65, 143536
    v_mov_b32 v22, s65
    v_mov_b32 v18, 143488
    s_cmp_eq_u32 s60, 0
    s_cbranch_scc1 L_b_skip0_8
    s_nop 1
    ds_write_b128 v20, v[92:95] offset:0
    ds_write_b128 v20, v[96:99] offset:1024
    ds_write_b128 v20, v[100:103] offset:2048
    ds_write_b128 v20, v[104:107] offset:3072
    ds_write_b128 v20, v[108:111] offset:4096
    ds_write_b128 v20, v[112:115] offset:5120
    ds_write_b128 v20, v[116:119] offset:6144
    ds_write_b128 v20, v[120:123] offset:7168
L_b_skip0_8:
    s_cmp_eq_u32 s60, 1
    s_cbranch_scc1 L_b_skip1_9
    s_nop 1
    ds_write_b128 v20, v[124:127] offset:8192
    ds_write_b128 v20, v[128:131] offset:9216
    ds_write_b128 v20, v[132:135] offset:10240
    ds_write_b128 v20, v[136:139] offset:11264
    ds_write_b128 v20, v[140:143] offset:12288
    ds_write_b128 v20, v[144:147] offset:13312
    ds_write_b128 v20, v[148:151] offset:14336
    ds_write_b128 v20, v[152:155] offset:15360
L_b_skip1_9:
    s_waitcnt lgkmcnt(0)
    s_cmp_ge_u32 s60, 2
    s_cselect_b32 s65, 2, 1
    v_mov_b32 v24, s65
    s_mov_b64 exec, 1
    ds_write_b32 v22, v24
    s_mov_b64 exec, -1
    s_cbranch_scc1 L_b67_done
    s_mov_b32 s99, 3200000
L_lw_12:
    ds_read_b128 v[24:27], v18 offset:48
    s_waitcnt lgkmcnt(0)
    v_min3_u32 v24, v24, v25, v26
    v_min_u32 v24, v24, v27
    s_nop 0
    v_readfirstlane_b32 s98, v24
    s_nop 1
    s_cmp_ge_u32 s98, 1
    s_cbranch_scc1 L_lw_done_13
    s_sub_u32 s99, s99, 1
    s_cbranch_scc1 L_lw_done_13
    s_sleep 1
    s_branch L_lw_12
L_lw_done_13:
    s_cmp_eq_u32 s60, 0
    s_cbranch_scc0 L_b_k1_10
    v_add_u32 v20, 114688, v23
    v_add_u32 v21, 147456, v23
    v_add_u32 v19, 16384, v23
    ds_read_b128 v[28:31], v20 offset:0
    ds_read_b128 v[32:35], v20 offset:1024
    ds_read_b128 v[36:39], v20 offset:2048
    ds_read_b128 v[40:43], v20 offset:3072
    ds_read_b128 v[44:47], v20 offset:4096
    ds_read_b128 v[48:51], v20 offset:5120
    ds_read_b128 v[52:55], v20 offset:6144
    ds_read_b128 v[56:59], v20 offset:7168
    ds_read_b128 v[60:63], v21 offset:0
    ds_read_b128 v[64:67], v21 offset:1024
    ds_read_b128 v[68:71], v21 offset:2048
    ds_read_b128 v[72:75], v21 offset:3072
    ds_read_b128 v[76:79], v21 offset:4096
    ds_read_b128 v[80:83], v21 offset:5120
    ds_read_b128 v[84:87], v21 offset:6144
    s_waitcnt lgkmcnt(7)
    ds_read_b128 v[88:91], v21 offset:7168
    v_add_f32 v92, v28, v92
    v_add_f32 v93, v29, v93
    v_add_f32 v94, v30, v94
    v_add_f32 v95, v31, v95
    v_add_f32 v96, v32, v96
    v_add_f32 v97, v33, v97
    v_add_f32 v98, v34, v98
    v_add_f32 v99, v35, v99
    v_add_f32 v100, v36, v100
    v_add_f32 v101, v37, v101
    v_add_f32 v102, v38, v102
    v_add_f32 v103, v39, v103
    v_add_f32 v104, v40, v104
    v_add_f32 v105, v41, v105
    v_add_f32 v106, v42, v106
    v_add_f32 v107, v43, v107
    v_add_f32 v108, v44, v108
    v_add_f32 v109, v45, v109
    v_add_f32 v110, v46, v110
    v_add_f32 v111, v47, v111
    v_add_f32 v112, v48, v112
    v_add_f32 v113, v49, v113
    v_add_f32 v114, v50, v114
    v_add_f32 v115, v51, v115
    v_add_f32 v116, v52, v116
    v_add_f32 v117, v53, v117
    v_add_f32 v118, v54, v118
    v_add_f32 v119, v55, v119
    v_add_f32 v120, v56, v120
    v_add_f32 v121, v57, v121
    v_add_f32 v122, v58, v122
    v_add_f32 v123, v59, v123
    ds_read_b128 v[28:31], v19 offset:0
    ds_read_b128 v[32:35], v19 offset:1024
    ds_read_b128 v[36:39], v19 offset:2048
    ds_read_b128 v[40:43], v19 offset:3072
    ds_read_b128 v[44:47], v19 offset:4096
    ds_read_b128 v[48:51], v19 offset:5120
    ds_read_b128 v[52:55], v19 offset:6144
    s_waitcnt lgkmcnt(7)
    ds_read_b128 v[56:59], v19 offset:7168
    v_add_f32 v92, v60, v92
    v_add_f32 v93, v61, v93
    v_add_f32 v94, v62, v94
    v_add_f32 v95, v63, v95
    v_add_f32 v96, v64, v96
    v_add_f32 v97, v65, v97
    v_add_f32 v98, v66, v98
    v_add_f32 v99, v67, v99
    v_add_f32 v100, v68, v100
    v_add_f32 v101, v69, v101
    v_add_f32 v102, v70, v102
    v_add_f32 v103, v71, v103
    v_add_f32 v104, v72, v104
    v_add_f32 v105, v73, v105
    v_add_f32 v106, v74, v106
    v_add_f32 v107, v75, v107
    v_add_f32 v108, v76, v108
    v_add_f32 v109, v77, v109
    v_add_f32 v110, v78, v110
    v_add_f32 v111, v79, v111
    v_add_f32 v112, v80, v112
    v_add_f32 v113, v81, v113
    v_add_f32 v114, v82, v114
    v_add_f32 v115, v83, v115
    v_add_f32 v116, v84, v116
    v_add_f32 v117, v85, v117
    v_add_f32 v118, v86, v118
    v_add_f32 v119, v87, v119
    v_add_f32 v120, v88, v120
    v_add_f32 v121, v89, v121
    v_add_f32 v122, v90, v122
    v_add_f32 v123, v91, v123
    s_waitcnt lgkmcnt(0)
    v_mov_b32 v24, 2
    s_mov_b64 exec, 1
    ds_write_b32 v22, v24
    s_mov_b64 exec, -1
    v_add_f32 v28, v28, v92
    v_add_f32 v29, v29, v93
    v_add_f32 v30, v30, v94
    v_add_f32 v31, v31, v95
    v_add_f32 v32, v32, v96
    v_add_f32 v33, v33, v97
    v_add_f32 v34, v34, v98
    v_add_f32 v35, v35, v99
    v_add_f32 v36, v36, v100
    v_add_f32 v37, v37, v101
    v_add_f32 v38, v38, v102
    v_add_f32 v39, v39, v103
    v_add_f32 v40, v40, v104
    v_add_f32 v41, v41, v105
    v_add_f32 v42, v42, v106
    v_add_f32 v43, v43, v107
    v_add_f32 v44, v44, v108
    v_add_f32 v45, v45, v109
    v_add_f32 v46, v46, v110
    v_add_f32 v47, v47, v111
    v_add_f32 v48, v48, v112
    v_add_f32 v49, v49, v113
    v_add_f32 v50, v50, v114
    v_add_f32 v51, v51, v115
    v_add_f32 v52, v52, v116
    v_add_f32 v53, v53, v117
    v_add_f32 v54, v54, v118
    v_add_f32 v55, v55, v119
    v_add_f32 v56, v56, v120
    v_add_f32 v57, v57, v121
    v_add_f32 v58, v58, v122
    v_add_f32 v59, v59, v123
    s_branch L_b_join_11
L_b_k1_10:
    v_add_u32 v20, 106496, v23
    v_add_u32 v21, 155648, v23
    v_add_u32 v19, 24576, v23
    ds_read_b128 v[28:31], v20 offset:0
    ds_read_b128 v[32:35], v20 offset:1024
    ds_read_b128 v[36:39], v20 offset:2048
    ds_read_b128 v[40:43], v20 offset:3072
    ds_read_b128 v[44:47], v20 offset:4096
    ds_read_b128 v[48:51], v20 offset:5120
    ds_read_b128 v[52:55], v20 offset:6144
    ds_read_b128 v[56:59], v20 offset:7168
    ds_read_b128 v[60:63], v21 offset:0
    ds_read_b128 v[64:67], v21 offset:1024
    ds_read_b128 v[68:71], v21 offset:2048
    ds_read_b128 v[72:75], v21 offset:3072
    ds_read_b128 v[76:79], v21 offset:4096
    ds_read_b128 v[80:83], v21 offset:5120
    ds_read_b128 v[84:87], v21 offset:6144
    s_waitcnt lgkmcnt(7)
    ds_read_b128 v[88:91], v21 offset:7168
    v_add_f32 v124, v28, v124
    v_add_f32 v125, v29, v125
    v_add_f32 v126, v30, v126
    v_add_f32 v127, v31, v127
    v_add_f32 v128, v32, v128
    v_add_f32 v129, v33, v129
    v_add_f32 v130, v34, v130
    v_add_f32 v131, v35, v131
    v_add_f32 v132, v36, v132
    v_add_f32 v133, v37, v133
    v_add_f32 v134, v38, v134
    v_add_f32 v135, v39, v135
    v_add_f32 v136, v40, v136
    v_add_f32 v137, v41, v137
    v_add_f32 v138, v42, v138
    v_add_f32 v139, v43, v139
    v_add_f32 v140, v44, v140
    v_add_f32 v141, v45, v141
    v_add_f32 v142, v46, v142
    v_add_f32 v143, v47, v143
    v_add_f32 v144, v48, v144
    v_add_f32 v145, v49, v145
    v_add_f32 v146, v50, v146
    v_add_f32 v147, v51, v147
    v_add_f32 v148, v52, v148
    v_add_f32 v149, v53, v149
    v_add_f32 v150, v54, v150
    v_add_f32 v151, v55, v151
    v_add_f32 v152, v56, v152
    v_add_f32 v153, v57, v153
    v_add_f32 v154, v58, v154
    v_add_f32 v155, v59, v155
    ds_read_b128 v[28:31], v19 offset:0
    ds_read_b128 v[32:35], v19 offset:1024
    ds_read_b128 v[36:39], v19 offset:2048
    ds_read_b128 v[40:43], v19 offset:3072
    ds_read_b128 v[44:47], v19 offset:4096
    ds_read_b128 v[48:51], v19 offset:5120
    ds_read_b128 v[52:55], v19 offset:6144
    s_waitcnt lgkmcnt(7)
    ds_read_b128 v[56:59], v19 offset:7168
    v_add_f32 v124, v60, v124
    v_add_f32 v125, v61, v125
    v_add_f32 v126, v62, v126
    v_add_f32 v127, v63, v127
    v_add_f32 v128, v64, v128
    v_add_f32 v129, v65, v129
    v_add_f32 v130, v66, v130
    v_add_f32 v131, v67, v131
    v_add_f32 v132, v68, v132
    v_add_f32 v133, v69, v133
    v_add_f32 v134, v70, v134
    v_add_f32 v135, v71, v135
    v_add_f32 v136, v72, v136
    v_add_f32 v137, v73, v137
    v_add_f32 v138, v74, v138
    v_add_f32 v139, v75, v139
    v_add_f32 v140, v76, v140
    v_add_f32 v141, v77, v141
    v_add_f32 v142, v78, v142
    v_add_f32 v143, v79, v143
    v_add_f32 v144, v80, v144
    v_add_f32 v145, v81, v145
    v_add_f32 v146, v82, v146
    v_add_f32 v147, v83, v147
    v_add_f32 v148, v84, v148
    v_add_f32 v149, v85, v149
    v_add_f32 v150, v86, v150
    v_add_f32 v151, v87, v151
    v_add_f32 v152, v88, v152
    v_add_f32 v153, v89, v153
    v_add_f32 v154, v90, v154
    v_add_f32 v155, v91, v155
    s_waitcnt lgkmcnt(0)
    v_mov_b32 v24, 2
    s_mov_b64 exec, 1
    ds_write_b32 v22, v24
    s_mov_b64 exec, -1
    v_add_f32 v28, v28, v124
    v_add_f32 v29, v29, v125
    v_add_f32 v30, v30, v126
    v_add_f32 v31, v31, v127
    v_add_f32 v32, v32, v128
    v_add_f32 v33, v33, v129
    v_add_f32 v34, v34, v130
    v_add_f32 v35, v35, v131
    v_add_f32 v36, v36, v132
    v_add_f32 v37, v37, v133
    v_add_f32 v38, v38, v134
    v_add_f32 v39, v39, v135
    v_add_f32 v40, v40, v136
    v_add_f32 v41, v41, v137
    v_add_f32 v42, v42, v138
    v_add_f32 v43, v43, v139
    v_add_f32 v44, v44, v140
    v_add_f32 v45, v45, v141
    v_add_f32 v46, v46, v142
    v_add_f32 v47, v47, v143
    v_add_f32 v48, v48, v144
    v_add_f32 v49, v49, v145
    v_add_f32 v50, v50, v146
    v_add_f32 v51, v51, v147
    v_add_f32 v52, v52, v148
    v_add_f32 v53, v53, v149
    v_add_f32 v54, v54, v150
    v_add_f32 v55, v55, v151
    v_add_f32 v56, v56, v152
    v_add_f32 v57, v57, v153
    v_add_f32 v58, v58, v154
    v_add_f32 v59, v59, v155
L_b_join_11:
    s_mov_b32 s99, 400000
    s_waitcnt vmcnt(0)
L_nonce_14:
    v_readfirstlane_b32 s26, v12
    v_readfirstlane_b32 s27, v13
    s_nop 1
    s_cmp_lg_u32 s26, 0
    s_cbranch_scc1 L_nonce_done_15
    s_sub_u32 s99, s99, 1
    s_cbranch_scc1 L_nonce_done_15
    s_sleep 1
    buffer_load_dwordx2 v[12:13], v14, s[40:43], 0 offen sc1
    s_waitcnt vmcnt(0)
    s_branch L_nonce_14
L_nonce_done_15:
    v_and_b32 v20, 15, v0
    s_lshl_b32 s65, s93, 4
    v_add_u32 v20, s65, v20
    v_cmp_eq_u32 vcc, 0, v20
    v_sub_u32 v21, 512, v20
    v_mov_b32 v22, 256
    v_lshrrev_b32 v23, 5, v0
    v_cndmask_b32 v21, v21, v22, vcc
    v_lshlrev_b32 v23, 18, v23
    v_and_b32 v22, 16, v0
    v_cmp_ne_u32 s[66:67], 0, v22
    v_mov_b32 v17, 1.0
    v_mov_b32 v22, -1.0
    v_cndmask_b32 v16, v20, v21, s[66:67]
    s_mov_b32 s70, 0
    s_mov_b32 s71, -1
    v_cndmask_b32 v17, v17, v22, s[70:71]
    v_lshrrev_b32 v22, 5, v16
    v_lshl_add_u32 v23, v22, 14, v23
    v_and_b32 v22, 31, v16
    v_lshl_add_u32 v16, v22, 4, v23
    v_lshlrev_b32 v18, 2, v20
    v_lshlrev_b32 v19, 2, v21
    v_add_f32 v22, v28, v44
    v_add_f32 v23, v36, v52
    v_add_f32 v60, v22, v23
    v_sub_f32 v76, v22, v23
    v_add_f32 v22, v32, v48
    v_add_f32 v23, v40, v56
    v_add_f32 v64, v22, v23
    v_sub_f32 v80, v22, v23
    v_sub_f32 v100, v28, v44
    v_sub_f32 v101, v36, v52
    v_sub_f32 v102, v32, v48
    v_sub_f32 v103, v40, v56
    v_add_f32 v68, v100, v103
    v_sub_f32 v72, v101, v102
    v_sub_f32 v88, v100, v103
    v_add_f32 v92, v101, v102
    v_cndmask_b32 v84, v60, v64, vcc
    v_cndmask_b32 v96, v76, v80, vcc
    v_cndmask_b32 v88, v88, v102, vcc
    v_cndmask_b32 v92, v92, v103, vcc
    v_cndmask_b32 v68, v68, v100, vcc
    v_cndmask_b32 v72, v72, v101, vcc
    v_cndmask_b32 v64, v64, v14, vcc
    v_cndmask_b32 v80, v80, v14, vcc
    v_add_f32 v22, v29, v45
    v_add_f32 v23, v37, v53
    v_add_f32 v61, v22, v23
    v_sub_f32 v77, v22, v23
    v_add_f32 v22, v33, v49
    v_add_f32 v23, v41, v57
    v_add_f32 v65, v22, v23
    v_sub_f32 v81, v22, v23
    v_sub_f32 v100, v29, v45
    v_sub_f32 v101, v37, v53
    v_sub_f32 v102, v33, v49
    v_sub_f32 v103, v41, v57
    v_add_f32 v69, v100, v103
    v_sub_f32 v73, v101, v102
    v_sub_f32 v89, v100, v103
    v_add_f32 v93, v101, v102
    v_cndmask_b32 v85, v61, v65, vcc
    v_cndmask_b32 v97, v77, v81, vcc
    v_cndmask_b32 v89, v89, v102, vcc
    v_cndmask_b32 v93, v93, v103, vcc
    v_cndmask_b32 v69, v69, v100, vcc
    v_cndmask_b32 v73, v73, v101, vcc
    v_cndmask_b32 v65, v65, v14, vcc
    v_cndmask_b32 v81, v81, v14, vcc
    v_add_f32 v22, v30, v46
    v_add_f32 v23, v38, v54
    v_add_f32 v62, v22, v23
    v_sub_f32 v78, v22, v23
    v_add_f32 v22, v34, v50
    v_add_f32 v23, v42, v58
    v_add_f32 v66, v22, v23
    v_sub_f32 v82, v22, v23
    v_sub_f32 v100, v30, v46
    v_sub_f32 v101, v38, v54
    v_sub_f32 v102, v34, v50
    v_sub_f32 v103, v42, v58
    v_add_f32 v70, v100, v103
    v_sub_f32 v74, v101, v102
    v_sub_f32 v90, v100, v103
    v_add_f32 v94, v101, v102
    v_cndmask_b32 v86, v62, v66, vcc
    v_cndmask_b32 v98, v78, v82, vcc
    v_cndmask_b32 v90, v90, v102, vcc
    v_cndmask_b32 v94, v94, v103, vcc
    v_cndmask_b32 v70, v70, v100, vcc
    v_cndmask_b32 v74, v74, v101, vcc
    v_cndmask_b32 v66, v66, v14, vcc
    v_cndmask_b32 v82, v82, v14, vcc
    v_add_f32 v22, v31, v47
    v_add_f32 v23, v39, v55
    v_add_f32 v63, v22, v23
    v_sub_f32 v79, v22, v23
    v_add_f32 v22, v35, v51
    v_add_f32 v23, v43, v59
    v_add_f32 v67, v22, v23
    v_sub_f32 v83, v22, v23
    v_sub_f32 v100, v31, v47
    v_sub_f32 v101, v39, v55
    v_sub_f32 v102, v35, v51
    v_sub_f32 v103, v43, v59
    v_add_f32 v71, v100, v103
    v_sub_f32 v75, v101, v102
    v_sub_f32 v91, v100, v103
    v_add_f32 v95, v101, v102
    v_cndmask_b32 v87, v63, v67, vcc
    v_cndmask_b32 v99, v79, v83, vcc
    v_cndmask_b32 v91, v91, v102, vcc
    v_cndmask_b32 v95, v95, v103, vcc
    v_cndmask_b32 v71, v71, v100, vcc
    v_cndmask_b32 v75, v75, v101, vcc
    v_cndmask_b32 v67, v67, v14, vcc
    v_cndmask_b32 v83, v83, v14, vcc
    v_add_f32 v136, v60, v61
    v_add_f32 v137, v62, v63
    v_add_f32 v136, v136, v137
    v_add_f32 v138, v84, v85
    v_add_f32 v139, v86, v87
    v_add_f32 v138, v138, v139
    v_mov_b32 v28, v64
    v_mov_b32 v32, v80
    v_mov_b32 v29, v65
    v_mov_b32 v33, v81
    v_mov_b32 v30, v66
    v_mov_b32 v34, v82
    v_mov_b32 v31, v67
    v_mov_b32 v35, v83
    s_cmp_lg_u32 s92, 0
    s_cbranch_scc1 L_b_nospecial_16
    s_mov_b64 exec, 0xffff
    v_mov_b32 v64, 0
    v_mov_b32 v28, 0
    v_mov_b32 v80, 0
    v_mov_b32 v32, 0
    v_mov_b32 v72, 0
    v_mov_b32 v92, 0
    s_mov_b32 exec_lo, 0
    s_mov_b32 exec_hi, 0xffff
    v_mov_b32 v64, v60
    v_sub_f32 v28, 0, v84
    v_sub_f32 v68, v72, v68
    v_sub_f32 v88, v92, v88
    v_mov_b32 v60, 0
    v_mov_b32 v84, 0
    v_mov_b32 v76, 0
    v_mov_b32 v96, 0
    v_mov_b32 v72, 0
    v_mov_b32 v92, 0
    s_mov_b64 exec, -1
L_b_nospecial_16:
    v_mov_b32 v36, v72
    v_mov_b32 v40, v92
    v_mov_b32 v37, v73
    v_mov_b32 v41, v93
    v_mov_b32 v38, v74
    v_mov_b32 v42, v94
    v_mov_b32 v39, v75
    v_mov_b32 v43, v95
    v_permlane32_swap_b32 v60, v64
    v_permlane32_swap_b32 v84, v28
    v_permlane32_swap_b32 v76, v80
    v_permlane32_swap_b32 v96, v32
    v_permlane32_swap_b32 v61, v65
    v_permlane32_swap_b32 v85, v29
    v_permlane32_swap_b32 v77, v81
    v_permlane32_swap_b32 v97, v33
    v_permlane32_swap_b32 v62, v66
    v_permlane32_swap_b32 v86, v30
    v_permlane32_swap_b32 v78, v82
    v_permlane32_swap_b32 v98, v34
    v_permlane32_swap_b32 v63, v67
    v_permlane32_swap_b32 v87, v31
    v_permlane32_swap_b32 v79, v83
    v_permlane32_swap_b32 v99, v35
    v_permlane32_swap_b32 v36, v72
    v_permlane32_swap_b32 v40, v92
    v_permlane32_swap_b32 v37, v73
    v_permlane32_swap_b32 v41, v93
    v_permlane32_swap_b32 v38, v74
    v_permlane32_swap_b32 v42, v94
    v_permlane32_swap_b32 v39, v75
    v_permlane32_swap_b32 v43, v95
    v_fma_f32 v60, v60, v17, v64
    v_fma_f32 v84, v28, v17, v84
    v_fma_f32 v76, v76, v17, -v80
    v_fma_f32 v96, v32, -v17, v96
    v_fma_f32 v61, v61, v17, v65
    v_fma_f32 v85, v29, v17, v85
    v_fma_f32 v77, v77, v17, -v81
    v_fma_f32 v97, v33, -v17, v97
    v_fma_f32 v62, v62, v17, v66
    v_fma_f32 v86, v30, v17, v86
    v_fma_f32 v78, v78, v17, -v82
    v_fma_f32 v98, v34, -v17, v98
    v_fma_f32 v63, v63, v17, v67
    v_fma_f32 v87, v31, v17, v87
    v_fma_f32 v79, v79, v17, -v83
    v_fma_f32 v99, v35, -v17, v99
    v_cndmask_b32 v72, v72, v36, s[70:71]
    v_cndmask_b32 v92, v92, v40, s[70:71]
    v_sub_f32 v68, v68, v72
    v_sub_f32 v88, v88, v92
    v_mul_f32 v68, v17, v68
    v_mul_f32 v88, v17, v88
    v_cndmask_b32 v73, v73, v37, s[70:71]
    v_cndmask_b32 v93, v93, v41, s[70:71]
    v_sub_f32 v69, v69, v73
    v_sub_f32 v89, v89, v93
    v_mul_f32 v69, v17, v69
    v_mul_f32 v89, v17, v89
    v_cndmask_b32 v74, v74, v38, s[70:71]
    v_cndmask_b32 v94, v94, v42, s[70:71]
    v_sub_f32 v70, v70, v74
    v_sub_f32 v90, v90, v94
    v_mul_f32 v70, v17, v70
    v_mul_f32 v90, v17, v90
    v_cndmask_b32 v75, v75, v39, s[70:71]
    v_cndmask_b32 v95, v95, v43, s[70:71]
    v_sub_f32 v71, v71, v75
    v_sub_f32 v91, v91, v95
    v_mul_f32 v71, v17, v71
    v_mul_f32 v91, v17, v91
    s_lshl_b32 s65, s92, 9
    s_add_u32 s65, s65, 8388608
    v_cvt_pk_bf16_f32 v112, v60, v61
    v_cvt_pk_bf16_f32 v113, v62, v63
    v_cvt_pk_bf16_f32 v114, v84, v85
    v_cvt_pk_bf16_f32 v115, v86, v87
    s_nop 0
    s_nop 0
    v_permlane16_swap_b32 v112, v114
    v_permlane16_swap_b32 v113, v115
    s_nop 1
    buffer_store_dwordx4 v[112:115], v16, s[36:39], s65 offen sc1
    v_cvt_pk_bf16_f32 v116, v68, v69
    v_cvt_pk_bf16_f32 v117, v70, v71
    v_cvt_pk_bf16_f32 v118, v88, v89
    v_cvt_pk_bf16_f32 v119, v90, v91
    s_add_u32 s65, s65, 524288
    s_nop 0
    v_permlane16_swap_b32 v116, v118
    v_permlane16_swap_b32 v117, v119
    s_nop 1
    buffer_store_dwordx4 v[116:119], v16, s[36:39], s65 offen sc1
    v_cvt_pk_bf16_f32 v120, v76, v77
    v_cvt_pk_bf16_f32 v121, v78, v79
    v_cvt_pk_bf16_f32 v122, v96, v97
    v_cvt_pk_bf16_f32 v123, v98, v99
    s_add_u32 s65, s65, 524288
    s_nop 0
    v_permlane16_swap_b32 v120, v122
    v_permlane16_swap_b32 v121, v123
    s_nop 1
    buffer_store_dwordx4 v[120:123], v16, s[36:39], s65 offen sc1
    v_mov_b32 v137, v136
    v_mov_b32 v139, v138
    s_nop 0
    v_permlane32_swap_b32 v136, v137
    v_permlane32_swap_b32 v138, v139
    s_nop 0
    v_add_f32 v136, v136, v137
    v_add_f32 v138, v138, v139
    v_mov_b32 v137, v136
    v_mov_b32 v139, v138
    s_nop 0
    v_permlane16_swap_b32 v136, v137
    v_permlane16_swap_b32 v138, v139
    s_nop 0
    v_add_f32 v136, v136, v137
    v_add_f32 v138, v138, v139
    s_lshl_b32 s65, s92, 11
    s_add_u32 s65, s65, 12582912
    s_mov_b64 exec, 0xffff
    buffer_store_dword v136, v18, s[36:39], s65 offen sc1
    buffer_store_dword v138, v19, s[36:39], s65 offen sc1
    s_mov_b64 exec, -1
    s_lshl_b32 s87, s2, 1
    s_add_u32 s87, s87, s60
    s_lshl_b32 s87, s87, 3
    s_add_u32 s87, s87, 22032384
    s_branch L_attn
L_b67_done:
    s_mov_b32 s99, 400000
    s_waitcnt vmcnt(0)
L_nonce_17:
    v_readfirstlane_b32 s26, v12
    v_readfirstlane_b32 s27, v13
    s_nop 1
    s_cmp_lg_u32 s26, 0
    s_cbranch_scc1 L_nonce_done_18
    s_sub_u32 s99, s99, 1
    s_cbranch_scc1 L_nonce_done_18
    s_sleep 1
    buffer_load_dwordx2 v[12:13], v14, s[40:43], 0 offen sc1
    s_waitcnt vmcnt(0)
    s_branch L_nonce_17
L_nonce_done_18:
    s_branch L_attn
L_computeA:
    s_setprio 3
    s_and_b32 s60, s3, 1
    s_lshr_b32 s61, s3, 1
    v_and_b32 v14, 31, v0
    s_lshl_b32 s62, s60, 12
    v_lshl_add_u32 v15, v14, 7, s62
    v_lshrrev_b32 v14, 1, v14
    v_and_b32 v14, 7, v14
    v_lshrrev_b32 v16, 5, v0
    v_xor_b32 v14, v14, v16
    v_lshl_add_u32 v4, v14, 4, v15
    v_xor_b32 v5, 32, v4
    v_xor_b32 v6, 64, v4
    v_xor_b32 v7, 96, v4
    v_lshlrev_b32 v15, 10, v16
    v_bfe_u32 v14, v0, 2, 2
    v_lshl_add_u32 v15, v14, 7, v15
    v_bfe_u32 v14, v0, 3, 1
    v_xor_b32 v14, s61, v14
    v_lshl_add_u32 v15, v14, 6, v15
    v_bfe_u32 v14, v0, 4, 1
    v_lshl_add_u32 v15, v14, 5, v15
    v_and_b32 v14, 3, v0
    v_lshl_add_u32 v15, v14, 3, v15
    v_add_u32 v12, 8192, v15
    v_mov_b32 v17, 0
    s_waitcnt lgkmcnt(0)
    s_mov_b32 s36, s24
    s_and_b32 s37, s25, 0xffff
    s_mov_b32 s38, 0x10000000
    s_mov_b32 s39, 0x20000
    s_mov_b32 s40, s22
    s_and_b32 s41, s23, 0xffff
    s_mov_b32 s42, 0x100
    s_mov_b32 s43, 0x20000
    v_mov_b32 v28, 0
    v_mov_b32 v29, 0
    v_mov_b32 v30, 0
    v_mov_b32 v31, 0
    v_mov_b32 v32, 0
    v_mov_b32 v33, 0
    v_mov_b32 v34, 0
    v_mov_b32 v35, 0
    v_mov_b32 v36, 0
    v_mov_b32 v37, 0
    v_mov_b32 v38, 0
    v_mov_b32 v39, 0
    v_mov_b32 v40, 0
    v_mov_b32 v41, 0
    v_mov_b32 v42, 0
    v_mov_b32 v43, 0
    v_mov_b32 v44, 0
    v_mov_b32 v45, 0
    v_mov_b32 v46, 0
    v_mov_b32 v47, 0
    v_mov_b32 v48, 0
    v_mov_b32 v49, 0
    v_mov_b32 v50, 0
    v_mov_b32 v51, 0
    v_mov_b32 v52, 0
    v_mov_b32 v53, 0
    v_mov_b32 v54, 0
    v_mov_b32 v55, 0
    v_mov_b32 v56, 0
    v_mov_b32 v57, 0
    v_mov_b32 v58, 0
    v_mov_b32 v59, 0
    v_mov_b32 v60, 0
    v_mov_b32 v61, 0
    v_mov_b32 v62, 0
    v_mov_b32 v63, 0
    v_mov_b32 v64, 0
    v_mov_b32 v65, 0
    v_mov_b32 v66, 0
    v_mov_b32 v67, 0
    v_mov_b32 v68, 0
    v_mov_b32 v69, 0
    v_mov_b32 v70, 0
    v_mov_b32 v71, 0
    v_mov_b32 v72, 0
    v_mov_b32 v73, 0
    v_mov_b32 v74, 0
    v_mov_b32 v75, 0
    v_lshlrev_b32 v23, 4, v0
    v_and_b32 v14, 0x33, v0
    v_bfe_u32 v15, v0, 2, 1
    v_lshl_or_b32 v14, v15, 3, v14
    v_bfe_u32 v15, v0, 3, 1
    v_lshl_or_b32 v14, v15, 2, v14
    v_lshlrev_b32 v24, 4, v14
    v_bfe_u32 v14, v0, 4, 1
    v_lshlrev_b32 v25, 16, v14
    v_lshrrev_b32 v14, 5, v0
    v_lshl_add_u32 v25, v14, 8, v25
    v_and_b32 v14, 15, v0
    v_lshl_add_u32 v25, v14, 4, v25
    s_lshl_b32 s62, s57, 1
    s_add_u32 s62, s62, s61
    s_lshl_b32 s63, s56, 1
    s_add_u32 s63, s63, s60
    s_lshl_b32 s64, s62, 17
    s_lshl_b32 s65, s63, 10
    s_add_u32 s64, s64, s65
    s_mov_b32 s66, 0x3eb8aa3b
    s_lshl_b32 s68, s62, 9
    s_lshl_b32 s69, s63, 3
    s_add_u32 s68, s68, s69
    s_add_u32 s68, s68, 22020096
    s_lshl_b32 s69, s3, 2
    s_add_u32 s69, s69, 143520
    v_mov_b32 v16, s69
    v_lshlrev_b32 v22, 3, v0
    s_lshl_b32 s70, s57, 8
    s_add_u32 s70, s70, 22052864
    s_lshl_b32 s71, s56, 3
    s_add_u32 s71, s71, s70
    s_getreg_b32 s72, hwreg(HW_REG_XCC_ID, 0, 4)
    v_add_u32 v8, 0, v4
    v_add_u32 v9, 0, v5
    v_add_u32 v10, 0, v6
    v_add_u32 v11, 0, v7
    v_add_u32 v13, 0, v12
    s_barrier
    ds_read_b128 v[76:79], v8
    ds_read_b64_tr_b16 v[92:93], v13 offset:8192
    ds_read_b64_tr_b16 v[94:95], v13 offset:8704
    ds_read_b64_tr_b16 v[96:97], v13 offset:16384
    ds_read_b64_tr_b16 v[98:99], v13 offset:16896
    ds_read_b64_tr_b16 v[88:89], v13 offset:0
    ds_read_b64_tr_b16 v[90:91], v13 offset:512
    ds_read_b128 v[80:83], v9
    ds_read_b64_tr_b16 v[104:105], v13 offset:10240
    ds_read_b64_tr_b16 v[106:107], v13 offset:10752
    ds_read_b64_tr_b16 v[108:109], v13 offset:18432
    ds_read_b64_tr_b16 v[110:111], v13 offset:18944
    ds_read_b64_tr_b16 v[100:101], v13 offset:2048
    ds_read_b64_tr_b16 v[102:103], v13 offset:2560
    s_waitcnt lgkmcnt(7)
    v_mfma_f32_32x32x16_bf16 v[44:59], v[92:95], v[76:79], v[44:59]
    ds_read_b128 v[84:87], v10
    ds_read_b64_tr_b16 v[116:117], v13 offset:12288
    ds_read_b64_tr_b16 v[118:119], v13 offset:12800
    v_mfma_f32_32x32x16_bf16 v[60:75], v[76:79], v[96:99], v[60:75]
    ds_read_b64_tr_b16 v[120:121], v13 offset:20480
    ds_read_b64_tr_b16 v[122:123], v13 offset:20992
    v_mfma_f32_32x32x16_bf16 v[28:43], v[88:91], v[76:79], v[28:43]
    ds_read_b64_tr_b16 v[112:113], v13 offset:4096
    ds_read_b64_tr_b16 v[114:115], v13 offset:4608
    s_waitcnt lgkmcnt(7)
    v_mfma_f32_32x32x16_bf16 v[44:59], v[104:107], v[80:83], v[44:59]
    ds_read_b128 v[76:79], v11
    ds_read_b64_tr_b16 v[92:93], v13 offset:14336
    ds_read_b64_tr_b16 v[94:95], v13 offset:14848
    v_mfma_f32_32x32x16_bf16 v[60:75], v[80:83], v[108:111], v[60:75]
    ds_read_b64_tr_b16 v[96:97], v13 offset:22528
    ds_read_b64_tr_b16 v[98:99], v13 offset:23040
    v_mfma_f32_32x32x16_bf16 v[28:43], v[100:103], v[80:83], v[28:43]
    ds_read_b64_tr_b16 v[88:89], v13 offset:6144
    ds_read_b64_tr_b16 v[90:91], v13 offset:6656
    s_waitcnt lgkmcnt(0)
    v_mfma_f32_32x32x16_bf16 v[44:59], v[116:119], v[84:87], v[44:59]
    v_add_u32 v8, 32768, v4
    v_add_u32 v9, 32768, v5
    v_add_u32 v10, 32768, v6
    v_add_u32 v11, 32768, v7
    v_add_u32 v13, 32768, v12
    v_mfma_f32_32x32x16_bf16 v[60:75], v[84:87], v[120:123], v[60:75]
    v_mfma_f32_32x32x16_bf16 v[28:43], v[112:115], v[84:87], v[28:43]
    s_barrier
    ds_read_b128 v[80:83], v8
    ds_read_b64_tr_b16 v[104:105], v13 offset:8192
    ds_read_b64_tr_b16 v[106:107], v13 offset:8704
    ds_read_b64_tr_b16 v[108:109], v13 offset:16384
    ds_read_b64_tr_b16 v[110:111], v13 offset:16896
    ds_read_b64_tr_b16 v[100:101], v13 offset:0
    ds_read_b64_tr_b16 v[102:103], v13 offset:512
    buffer_load_dwordx2 v[18:19], v17, s[40:43], 0 offen sc1
    v_mfma_f32_32x32x16_bf16 v[44:59], v[92:95], v[76:79], v[44:59]
    ds_read_b128 v[84:87], v9
    ds_read_b64_tr_b16 v[116:117], v13 offset:10240
    ds_read_b64_tr_b16 v[118:119], v13 offset:10752
    v_mfma_f32_32x32x16_bf16 v[60:75], v[76:79], v[96:99], v[60:75]
    ds_read_b64_tr_b16 v[120:121], v13 offset:18432
    ds_read_b64_tr_b16 v[122:123], v13 offset:18944
    v_mfma_f32_32x32x16_bf16 v[28:43], v[88:91], v[76:79], v[28:43]
    ds_read_b64_tr_b16 v[112:113], v13 offset:2048
    ds_read_b64_tr_b16 v[114:115], v13 offset:2560
    s_waitcnt lgkmcnt(7)
    v_mfma_f32_32x32x16_bf16 v[44:59], v[104:107], v[80:83], v[44:59]
    ds_read_b128 v[76:79], v10
    ds_read_b64_tr_b16 v[92:93], v13 offset:12288
    ds_read_b64_tr_b16 v[94:95], v13 offset:12800
    v_mfma_f32_32x32x16_bf16 v[60:75], v[80:83], v[108:111], v[60:75]
    ds_read_b64_tr_b16 v[96:97], v13 offset:20480
    ds_read_b64_tr_b16 v[98:99], v13 offset:20992
    v_mfma_f32_32x32x16_bf16 v[28:43], v[100:103], v[80:83], v[28:43]
    ds_read_b64_tr_b16 v[88:89], v13 offset:4096
    ds_read_b64_tr_b16 v[90:91], v13 offset:4608
    s_waitcnt lgkmcnt(7)
    v_mfma_f32_32x32x16_bf16 v[44:59], v[116:119], v[84:87], v[44:59]
    ds_read_b128 v[80:83], v11
    ds_read_b64_tr_b16 v[104:105], v13 offset:14336
    ds_read_b64_tr_b16 v[106:107], v13 offset:14848
    v_mfma_f32_32x32x16_bf16 v[60:75], v[84:87], v[120:123], v[60:75]
    ds_read_b64_tr_b16 v[108:109], v13 offset:22528
    ds_read_b64_tr_b16 v[110:111], v13 offset:23040
    v_mfma_f32_32x32x16_bf16 v[28:43], v[112:115], v[84:87], v[28:43]
    ds_read_b64_tr_b16 v[100:101], v13 offset:6144
    ds_read_b64_tr_b16 v[102:103], v13 offset:6656
    s_waitcnt lgkmcnt(0)
    v_mfma_f32_32x32x16_bf16 v[44:59], v[92:95], v[76:79], v[44:59]
    v_add_u32 v8, 65536, v4
    v_add_u32 v9, 65536, v5
    v_add_u32 v10, 65536, v6
    v_add_u32 v11, 65536, v7
    v_add_u32 v13, 65536, v12
    v_mfma_f32_32x32x16_bf16 v[60:75], v[76:79], v[96:99], v[60:75]
    v_mfma_f32_32x32x16_bf16 v[28:43], v[88:91], v[76:79], v[28:43]
    s_barrier
    ds_read_b128 v[84:87], v8
    ds_read_b64_tr_b16 v[116:117], v13 offset:8192
    ds_read_b64_tr_b16 v[118:119], v13 offset:8704
    ds_read_b64_tr_b16 v[120:121], v13 offset:16384
    ds_read_b64_tr_b16 v[122:123], v13 offset:16896
    ds_read_b64_tr_b16 v[112:113], v13 offset:0
    ds_read_b64_tr_b16 v[114:115], v13 offset:512
    v_mfma_f32_32x32x16_bf16 v[44:59], v[104:107], v[80:83], v[44:59]
    ds_read_b128 v[76:79], v9
    ds_read_b64_tr_b16 v[92:93], v13 offset:10240
    ds_read_b64_tr_b16 v[94:95], v13 offset:10752
    v_mfma_f32_32x32x16_bf16 v[60:75], v[80:83], v[108:111], v[60:75]
    ds_read_b64_tr_b16 v[96:97], v13 offset:18432
    ds_read_b64_tr_b16 v[98:99], v13 offset:18944
    v_mfma_f32_32x32x16_bf16 v[28:43], v[100:103], v[80:83], v[28:43]
    ds_read_b64_tr_b16 v[88:89], v13 offset:2048
    ds_read_b64_tr_b16 v[90:91], v13 offset:2560
    s_waitcnt lgkmcnt(7)
    v_mfma_f32_32x32x16_bf16 v[44:59], v[116:119], v[84:87], v[44:59]
    ds_read_b128 v[80:83], v10
    ds_read_b64_tr_b16 v[104:105], v13 offset:12288
    ds_read_b64_tr_b16 v[106:107], v13 offset:12800
    v_mfma_f32_32x32x16_bf16 v[60:75], v[84:87], v[120:123], v[60:75]
    ds_read_b64_tr_b16 v[108:109], v13 offset:20480
    ds_read_b64_tr_b16 v[110:111], v13 offset:20992
    v_mfma_f32_32x32x16_bf16 v[28:43], v[112:115], v[84:87], v[28:43]
    ds_read_b64_tr_b16 v[100:101], v13 offset:4096
    ds_read_b64_tr_b16 v[102:103], v13 offset:4608
    s_waitcnt lgkmcnt(7)
    v_mfma_f32_32x32x16_bf16 v[44:59], v[92:95], v[76:79], v[44:59]
    ds_read_b128 v[84:87], v11
    ds_read_b64_tr_b16 v[116:117], v13 offset:14336
    ds_read_b64_tr_b16 v[118:119], v13 offset:14848
    v_mfma_f32_32x32x16_bf16 v[60:75], v[76:79], v[96:99], v[60:75]
    ds_read_b64_tr_b16 v[120:121], v13 offset:22528
    ds_read_b64_tr_b16 v[122:123], v13 offset:23040
    v_mfma_f32_32x32x16_bf16 v[28:43], v[88:91], v[76:79], v[28:43]
    ds_read_b64_tr_b16 v[112:113], v13 offset:6144
    ds_read_b64_tr_b16 v[114:115], v13 offset:6656
    s_waitcnt lgkmcnt(0)
    v_mfma_f32_32x32x16_bf16 v[44:59], v[104:107], v[80:83], v[44:59]
    v_add_u32 v8, 98304, v4
    v_add_u32 v9, 98304, v5
    v_add_u32 v10, 98304, v6
    v_add_u32 v11, 98304, v7
    v_add_u32 v13, 98304, v12
    v_mfma_f32_32x32x16_bf16 v[60:75], v[80:83], v[108:111], v[60:75]
    v_mfma_f32_32x32x16_bf16 v[28:43], v[100:103], v[80:83], v[28:43]
    s_barrier
    ds_read_b128 v[76:79], v8
    ds_read_b64_tr_b16 v[92:93], v13 offset:8192
    ds_read_b64_tr_b16 v[94:95], v13 offset:8704
    ds_read_b64_tr_b16 v[96:97], v13 offset:16384
    ds_read_b64_tr_b16 v[98:99], v13 offset:16896
    ds_read_b64_tr_b16 v[88:89], v13 offset:0
    ds_read_b64_tr_b16 v[90:91], v13 offset:512
    s_mov_b32 s99, 400000
    s_waitcnt vmcnt(0)
L_nonce_19:
    v_readfirstlane_b32 s26, v18
    v_readfirstlane_b32 s27, v19
    s_nop 1
    s_cmp_lg_u32 s26, 0
    s_cbranch_scc1 L_nonce_done_20
    s_sub_u32 s99, s99, 1
    s_cbranch_scc1 L_nonce_done_20
    s_sleep 1
    buffer_load_dwordx2 v[18:19], v17, s[40:43], 0 offen sc1
    s_waitcnt vmcnt(0)
    s_branch L_nonce_19
L_nonce_done_20:
    s_xor_b32 s73, s27, s72
    s_cmp_lg_u32 s3, 0
    s_cbranch_scc1 L_xcc_skip_21
    v_mov_b32 v19, s73
    s_mov_b64 exec, 1
    buffer_store_dwordx2 v[18:19], v17, s[36:39], s71 offen sc1
    s_mov_b64 exec, -1
L_xcc_skip_21:
    v_mfma_f32_32x32x16_bf16 v[44:59], v[116:119], v[84:87], v[44:59]
    ds_read_b128 v[80:83], v9
    ds_read_b64_tr_b16 v[104:105], v13 offset:10240
    ds_read_b64_tr_b16 v[106:107], v13 offset:10752
    v_mfma_f32_32x32x16_bf16 v[60:75], v[84:87], v[120:123], v[60:75]
    ds_read_b64_tr_b16 v[108:109], v13 offset:18432
    ds_read_b64_tr_b16 v[110:111], v13 offset:18944
    v_mfma_f32_32x32x16_bf16 v[28:43], v[112:115], v[84:87], v[28:43]
    ds_read_b64_tr_b16 v[100:101], v13 offset:2048
    ds_read_b64_tr_b16 v[102:103], v13 offset:2560
    s_waitcnt lgkmcnt(7)
    v_mfma_f32_32x32x16_bf16 v[44:59], v[92:95], v[76:79], v[44:59]
    ds_read_b128 v[84:87], v10
    ds_read_b64_tr_b16 v[116:117], v13 offset:12288
    ds_read_b64_tr_b16 v[118:119], v13 offset:12800
    v_mfma_f32_32x32x16_bf16 v[60:75], v[76:79], v[96:99], v[60:75]
    ds_read_b64_tr_b16 v[120:121], v13 offset:20480
    ds_read_b64_tr_b16 v[122:123], v13 offset:20992
    v_mfma_f32_32x32x16_bf16 v[28:43], v[88:91], v[76:79], v[28:43]
    ds_read_b64_tr_b16 v[112:113], v13 offset:4096
    ds_read_b64_tr_b16 v[114:115], v13 offset:4608
    s_waitcnt lgkmcnt(7)
    v_mfma_f32_32x32x16_bf16 v[44:59], v[104:107], v[80:83], v[44:59]
    ds_read_b128 v[76:79], v11
    ds_read_b64_tr_b16 v[92:93], v13 offset:14336
    ds_read_b64_tr_b16 v[94:95], v13 offset:14848
    v_mfma_f32_32x32x16_bf16 v[60:75], v[80:83], v[108:111], v[60:75]
    ds_read_b64_tr_b16 v[96:97], v13 offset:22528
    ds_read_b64_tr_b16 v[98:99], v13 offset:23040
    v_mfma_f32_32x32x16_bf16 v[28:43], v[100:103], v[80:83], v[28:43]
    ds_read_b64_tr_b16 v[88:89], v13 offset:6144
    ds_read_b64_tr_b16 v[90:91], v13 offset:6656
    s_waitcnt lgkmcnt(0)
    v_mfma_f32_32x32x16_bf16 v[44:59], v[116:119], v[84:87], v[44:59]
    v_add_u32 v8, 131072, v4
    v_add_u32 v9, 131072, v5
    v_add_u32 v10, 131072, v6
    v_add_u32 v11, 131072, v7
    v_add_u32 v13, 131072, v12
    v_mfma_f32_32x32x16_bf16 v[60:75], v[84:87], v[120:123], v[60:75]
    v_mfma_f32_32x32x16_bf16 v[28:43], v[112:115], v[84:87], v[28:43]
    s_barrier
    ds_read_b128 v[80:83], v8
    ds_read_b64_tr_b16 v[104:105], v13 offset:8192
    ds_read_b64_tr_b16 v[106:107], v13 offset:8704
    ds_read_b64_tr_b16 v[108:109], v13 offset:16384
    ds_read_b64_tr_b16 v[110:111], v13 offset:16896
    ds_read_b64_tr_b16 v[100:101], v13 offset:0
    ds_read_b64_tr_b16 v[102:103], v13 offset:512
    v_mfma_f32_32x32x16_bf16 v[44:59], v[92:95], v[76:79], v[44:59]
    ds_read_b128 v[84:87], v9
    ds_read_b64_tr_b16 v[116:117], v13 offset:10240
    ds_read_b64_tr_b16 v[118:119], v13 offset:10752
    v_mfma_f32_32x32x16_bf16 v[60:75], v[76:79], v[96:99], v[60:75]
    ds_read_b64_tr_b16 v[120:121], v13 offset:18432
    ds_read_b64_tr_b16 v[122:123], v13 offset:18944
    v_mfma_f32_32x32x16_bf16 v[28:43], v[88:91], v[76:79], v[28:43]
    ds_read_b64_tr_b16 v[112:113], v13 offset:2048
    ds_read_b64_tr_b16 v[114:115], v13 offset:2560
    s_waitcnt lgkmcnt(7)
    v_mfma_f32_32x32x16_bf16 v[44:59], v[104:107], v[80:83], v[44:59]
    ds_read_b128 v[76:79], v10
    ds_read_b64_tr_b16 v[92:93], v13 offset:12288
    ds_read_b64_tr_b16 v[94:95], v13 offset:12800
    v_mfma_f32_32x32x16_bf16 v[60:75], v[80:83], v[108:111], v[60:75]
    ds_read_b64_tr_b16 v[96:97], v13 offset:20480
    ds_read_b64_tr_b16 v[98:99], v13 offset:20992
    v_mfma_f32_32x32x16_bf16 v[28:43], v[100:103], v[80:83], v[28:43]
    ds_read_b64_tr_b16 v[88:89], v13 offset:4096
    ds_read_b64_tr_b16 v[90:91], v13 offset:4608
    s_waitcnt lgkmcnt(7)
    v_mfma_f32_32x32x16_bf16 v[44:59], v[116:119], v[84:87], v[44:59]
    ds_read_b128 v[80:83], v11
    ds_read_b64_tr_b16 v[104:105], v13 offset:14336
    ds_read_b64_tr_b16 v[106:107], v13 offset:14848
    v_mfma_f32_32x32x16_bf16 v[60:75], v[84:87], v[120:123], v[60:75]
    ds_read_b64_tr_b16 v[108:109], v13 offset:22528
    ds_read_b64_tr_b16 v[110:111], v13 offset:23040
    v_mfma_f32_32x32x16_bf16 v[28:43], v[112:115], v[84:87], v[28:43]
    ds_read_b64_tr_b16 v[100:101], v13 offset:6144
    ds_read_b64_tr_b16 v[102:103], v13 offset:6656
    s_waitcnt lgkmcnt(0)
    v_mfma_f32_32x32x16_bf16 v[44:59], v[92:95], v[76:79], v[44:59]
    v_add_u32 v8, 0, v4
    v_add_u32 v9, 0, v5
    v_add_u32 v10, 0, v6
    v_add_u32 v11, 0, v7
    v_add_u32 v13, 0, v12
    v_mfma_f32_32x32x16_bf16 v[60:75], v[76:79], v[96:99], v[60:75]
    v_mfma_f32_32x32x16_bf16 v[28:43], v[88:91], v[76:79], v[28:43]
    s_barrier
    ds_read_b128 v[84:87], v8
    ds_read_b64_tr_b16 v[116:117], v13 offset:8192
    ds_read_b64_tr_b16 v[118:119], v13 offset:8704
    ds_read_b64_tr_b16 v[120:121], v13 offset:16384
    ds_read_b64_tr_b16 v[122:123], v13 offset:16896
    ds_read_b64_tr_b16 v[112:113], v13 offset:0
    ds_read_b64_tr_b16 v[114:115], v13 offset:512
    v_mfma_f32_32x32x16_bf16 v[44:59], v[104:107], v[80:83], v[44:59]
    ds_read_b128 v[76:79], v9
    ds_read_b64_tr_b16 v[92:93], v13 offset:10240
    ds_read_b64_tr_b16 v[94:95], v13 offset:10752
    v_mfma_f32_32x32x16_bf16 v[60:75], v[80:83], v[108:111], v[60:75]
    ds_read_b64_tr_b16 v[96:97], v13 offset:18432
    ds_read_b64_tr_b16 v[98:99], v13 offset:18944
    v_mfma_f32_32x32x16_bf16 v[28:43], v[100:103], v[80:83], v[28:43]
    ds_read_b64_tr_b16 v[88:89], v13 offset:2048
    ds_read_b64_tr_b16 v[90:91], v13 offset:2560
    s_waitcnt lgkmcnt(7)
    v_mfma_f32_32x32x16_bf16 v[44:59], v[116:119], v[84:87], v[44:59]
    ds_read_b128 v[80:83], v10
    ds_read_b64_tr_b16 v[104:105], v13 offset:12288
    ds_read_b64_tr_b16 v[106:107], v13 offset:12800
    v_mfma_f32_32x32x16_bf16 v[60:75], v[84:87], v[120:123], v[60:75]
    ds_read_b64_tr_b16 v[108:109], v13 offset:20480
    ds_read_b64_tr_b16 v[110:111], v13 offset:20992
    v_mfma_f32_32x32x16_bf16 v[28:43], v[112:115], v[84:87], v[28:43]
    ds_read_b64_tr_b16 v[100:101], v13 offset:4096
    ds_read_b64_tr_b16 v[102:103], v13 offset:4608
    s_waitcnt lgkmcnt(7)
    v_mfma_f32_32x32x16_bf16 v[44:59], v[92:95], v[76:79], v[44:59]
    ds_read_b128 v[84:87], v11
    ds_read_b64_tr_b16 v[116:117], v13 offset:14336
    ds_read_b64_tr_b16 v[118:119], v13 offset:14848
    v_mfma_f32_32x32x16_bf16 v[60:75], v[76:79], v[96:99], v[60:75]
    ds_read_b64_tr_b16 v[120:121], v13 offset:22528
    ds_read_b64_tr_b16 v[122:123], v13 offset:23040
    v_mfma_f32_32x32x16_bf16 v[28:43], v[88:91], v[76:79], v[28:43]
    ds_read_b64_tr_b16 v[112:113], v13 offset:6144
    ds_read_b64_tr_b16 v[114:115], v13 offset:6656
    s_waitcnt lgkmcnt(0)
    v_mfma_f32_32x32x16_bf16 v[44:59], v[104:107], v[80:83], v[44:59]
    v_add_u32 v8, 32768, v4
    v_add_u32 v9, 32768, v5
    v_add_u32 v10, 32768, v6
    v_add_u32 v11, 32768, v7
    v_add_u32 v13, 32768, v12
    v_mfma_f32_32x32x16_bf16 v[60:75], v[80:83], v[108:111], v[60:75]
    v_mfma_f32_32x32x16_bf16 v[28:43], v[100:103], v[80:83], v[28:43]
    s_barrier
    ds_read_b128 v[76:79], v8
    ds_read_b64_tr_b16 v[92:93], v13 offset:8192
    ds_read_b64_tr_b16 v[94:95], v13 offset:8704
    ds_read_b64_tr_b16 v[96:97], v13 offset:16384
    ds_read_b64_tr_b16 v[98:99], v13 offset:16896
    ds_read_b64_tr_b16 v[88:89], v13 offset:0
    ds_read_b64_tr_b16 v[90:91], v13 offset:512
    buffer_load_dwordx2 v[20:21], v22, s[36:39], s70 offen sc1
    v_mfma_f32_32x32x16_bf16 v[44:59], v[116:119], v[84:87], v[44:59]
    ds_read_b128 v[80:83], v9
    ds_read_b64_tr_b16 v[104:105], v13 offset:10240
    ds_read_b64_tr_b16 v[106:107], v13 offset:10752
    v_mfma_f32_32x32x16_bf16 v[60:75], v[84:87], v[120:123], v[60:75]
    ds_read_b64_tr_b16 v[108:109], v13 offset:18432
    ds_read_b64_tr_b16 v[110:111], v13 offset:18944
    v_mfma_f32_32x32x16_bf16 v[28:43], v[112:115], v[84:87], v[28:43]
    ds_read_b64_tr_b16 v[100:101], v13 offset:2048
    ds_read_b64_tr_b16 v[102:103], v13 offset:2560
    s_waitcnt lgkmcnt(7)
    v_mfma_f32_32x32x16_bf16 v[44:59], v[92:95], v[76:79], v[44:59]
    ds_read_b128 v[84:87], v10
    ds_read_b64_tr_b16 v[116:117], v13 offset:12288
    ds_read_b64_tr_b16 v[118:119], v13 offset:12800
    v_mfma_f32_32x32x16_bf16 v[60:75], v[76:79], v[96:99], v[60:75]
    ds_read_b64_tr_b16 v[120:121], v13 offset:20480
    ds_read_b64_tr_b16 v[122:123], v13 offset:20992
    v_mfma_f32_32x32x16_bf16 v[28:43], v[88:91], v[76:79], v[28:43]
    ds_read_b64_tr_b16 v[112:113], v13 offset:4096
    ds_read_b64_tr_b16 v[114:115], v13 offset:4608
    s_waitcnt lgkmcnt(7)
    v_mfma_f32_32x32x16_bf16 v[44:59], v[104:107], v[80:83], v[44:59]
    ds_read_b128 v[76:79], v11
    ds_read_b64_tr_b16 v[92:93], v13 offset:14336
    ds_read_b64_tr_b16 v[94:95], v13 offset:14848
    v_mfma_f32_32x32x16_bf16 v[60:75], v[80:83], v[108:111], v[60:75]
    ds_read_b64_tr_b16 v[96:97], v13 offset:22528
    ds_read_b64_tr_b16 v[98:99], v13 offset:23040
    v_mfma_f32_32x32x16_bf16 v[28:43], v[100:103], v[80:83], v[28:43]
    ds_read_b64_tr_b16 v[88:89], v13 offset:6144
    ds_read_b64_tr_b16 v[90:91], v13 offset:6656
    s_waitcnt lgkmcnt(0)
    v_mfma_f32_32x32x16_bf16 v[44:59], v[116:119], v[84:87], v[44:59]
    v_add_u32 v8, 65536, v4
    v_add_u32 v9, 65536, v5
    v_add_u32 v10, 65536, v6
    v_add_u32 v11, 65536, v7
    v_add_u32 v13, 65536, v12
    v_mfma_f32_32x32x16_bf16 v[60:75], v[84:87], v[120:123], v[60:75]
    v_mfma_f32_32x32x16_bf16 v[28:43], v[112:115], v[84:87], v[28:43]
    s_barrier
    ds_read_b128 v[80:83], v8
    ds_read_b64_tr_b16 v[104:105], v13 offset:8192
    ds_read_b64_tr_b16 v[106:107], v13 offset:8704
    ds_read_b64_tr_b16 v[108:109], v13 offset:16384
    ds_read_b64_tr_b16 v[110:111], v13 offset:16896
    ds_read_b64_tr_b16 v[100:101], v13 offset:0
    ds_read_b64_tr_b16 v[102:103], v13 offset:512
    v_mfma_f32_32x32x16_bf16 v[44:59], v[92:95], v[76:79], v[44:59]
    ds_read_b128 v[84:87], v9
    ds_read_b64_tr_b16 v[116:117], v13 offset:10240
    ds_read_b64_tr_b16 v[118:119], v13 offset:10752
    v_mfma_f32_32x32x16_bf16 v[60:75], v[76:79], v[96:99], v[60:75]
    ds_read_b64_tr_b16 v[120:121], v13 offset:18432
    ds_read_b64_tr_b16 v[122:123], v13 offset:18944
    v_mfma_f32_32x32x16_bf16 v[28:43], v[88:91], v[76:79], v[28:43]
    ds_read_b64_tr_b16 v[112:113], v13 offset:2048
    ds_read_b64_tr_b16 v[114:115], v13 offset:2560
    s_waitcnt lgkmcnt(7)
    v_mfma_f32_32x32x16_bf16 v[44:59], v[104:107], v[80:83], v[44:59]
    ds_read_b128 v[76:79], v10
    ds_read_b64_tr_b16 v[92:93], v13 offset:12288
    ds_read_b64_tr_b16 v[94:95], v13 offset:12800
    v_mfma_f32_32x32x16_bf16 v[60:75], v[80:83], v[108:111], v[60:75]
    ds_read_b64_tr_b16 v[96:97], v13 offset:20480
    ds_read_b64_tr_b16 v[98:99], v13 offset:20992
    v_mfma_f32_32x32x16_bf16 v[28:43], v[100:103], v[80:83], v[28:43]
    ds_read_b64_tr_b16 v[88:89], v13 offset:4096
    ds_read_b64_tr_b16 v[90:91], v13 offset:4608
    s_waitcnt lgkmcnt(7)
    v_mfma_f32_32x32x16_bf16 v[44:59], v[116:119], v[84:87], v[44:59]
    ds_read_b128 v[80:83], v11
    ds_read_b64_tr_b16 v[104:105], v13 offset:14336
    ds_read_b64_tr_b16 v[106:107], v13 offset:14848
    v_mfma_f32_32x32x16_bf16 v[60:75], v[84:87], v[120:123], v[60:75]
    ds_read_b64_tr_b16 v[108:109], v13 offset:22528
    ds_read_b64_tr_b16 v[110:111], v13 offset:23040
    v_mfma_f32_32x32x16_bf16 v[28:43], v[112:115], v[84:87], v[28:43]
    ds_read_b64_tr_b16 v[100:101], v13 offset:6144
    ds_read_b64_tr_b16 v[102:103], v13 offset:6656
    s_waitcnt lgkmcnt(0)
    v_mfma_f32_32x32x16_bf16 v[44:59], v[92:95], v[76:79], v[44:59]
    v_mfma_f32_32x32x16_bf16 v[60:75], v[76:79], v[96:99], v[60:75]
    v_mfma_f32_32x32x16_bf16 v[28:43], v[88:91], v[76:79], v[28:43]
    v_mfma_f32_32x32x16_bf16 v[44:59], v[104:107], v[80:83], v[44:59]
    v_mfma_f32_32x32x16_bf16 v[60:75], v[80:83], v[108:111], v[60:75]
    v_mfma_f32_32x32x16_bf16 v[28:43], v[100:103], v[80:83], v[28:43]
    s_mov_b32 s99, 400000
    s_add_u32 s65, s64, 2097152
    s_add_u32 s67, s64, 2162688
L_xcc_poll_22:
    s_waitcnt vmcnt(0)
    v_cmp_eq_u32 vcc, s26, v20
    v_cmp_eq_u32 s[96:97], s73, v21
    s_cmp_eq_u32 vcc_lo, -1
    s_cbranch_scc1 L_xcc_ok_23
    s_mov_b32 s96, 0
    s_sub_u32 s99, s99, 1
    s_cbranch_scc1 L_xcc_ok_23
    s_sleep 2
    buffer_load_dwordx2 v[20:21], v22, s[36:39], s70 offen sc1
    s_branch L_xcc_poll_22
L_xcc_ok_23:
    s_nop 1
    v_cvt_pk_bf16_f32 v88, v44, v45
    v_cvt_pk_bf16_f32 v89, v46, v47
    v_cvt_pk_bf16_f32 v90, v48, v49
    v_cvt_pk_bf16_f32 v91, v50, v51
    v_cvt_pk_bf16_f32 v92, v52, v53
    v_cvt_pk_bf16_f32 v93, v54, v55
    v_cvt_pk_bf16_f32 v94, v56, v57
    v_cvt_pk_bf16_f32 v95, v58, v59
    s_cmp_eq_u32 s96, -1
    s_cbranch_scc0 L_epi_slow_24
    buffer_store_dwordx4 v[88:91], v24, s[36:39], s65 offen
    buffer_store_dwordx4 v[92:95], v24, s[36:39], s67 offen
    v_cvt_pk_bf16_f32 v96, v60, v61
    v_cvt_pk_bf16_f32 v97, v62, v63
    v_cvt_pk_bf16_f32 v98, v64, v65
    v_cvt_pk_bf16_f32 v99, v66, v67
    v_cvt_pk_bf16_f32 v100, v68, v69
    v_cvt_pk_bf16_f32 v101, v70, v71
    v_cvt_pk_bf16_f32 v102, v72, v73
    v_cvt_pk_bf16_f32 v103, v74, v75
    s_add_u32 s65, s64, 4194304
    buffer_store_dwordx4 v[96:99], v25, s[36:39], s65 offen
    buffer_store_dwordx4 v[100:103], v25, s[36:39], s65 offen offset:512
    v_mul_f32 v28, s66, v28
    v_mul_f32 v29, s66, v29
    v_mul_f32 v30, s66, v30
    v_mul_f32 v31, s66, v31
    v_mul_f32 v32, s66, v32
    v_mul_f32 v33, s66, v33
    v_mul_f32 v34, s66, v34
    v_mul_f32 v35, s66, v35
    v_mul_f32 v36, s66, v36
    v_mul_f32 v37, s66, v37
    v_mul_f32 v38, s66, v38
    v_mul_f32 v39, s66, v39
    v_mul_f32 v40, s66, v40
    v_mul_f32 v41, s66, v41
    v_mul_f32 v42, s66, v42
    v_mul_f32 v43, s66, v43
    v_cvt_pk_bf16_f32 v104, v28, v29
    v_cvt_pk_bf16_f32 v105, v30, v31
    v_cvt_pk_bf16_f32 v106, v32, v33
    v_cvt_pk_bf16_f32 v107, v34, v35
    v_cvt_pk_bf16_f32 v108, v36, v37
    v_cvt_pk_bf16_f32 v109, v38, v39
    v_cvt_pk_bf16_f32 v110, v40, v41
    v_cvt_pk_bf16_f32 v111, v42, v43
    s_add_u32 s65, s64, 0
    s_add_u32 s67, s64, 65536
    buffer_store_dwordx4 v[104:107], v23, s[36:39], s65 offen
    buffer_store_dwordx4 v[108:111], v23, s[36:39], s67 offen
    v_mov_b32 v18, s26
    v_mov_b32 v19, s27
    s_waitcnt vmcnt(0)
    s_mov_b64 exec, 1
    buffer_store_dwordx2 v[18:19], v17, s[36:39], s68 offen
    s_mov_b64 exec, -1
    s_branch L_epi_done_25
L_epi_slow_24:
    buffer_store_dwordx4 v[88:91], v24, s[36:39], s65 offen sc1
    buffer_store_dwordx4 v[92:95], v24, s[36:39], s67 offen sc1
    v_cvt_pk_bf16_f32 v96, v60, v61
    v_cvt_pk_bf16_f32 v97, v62, v63
    v_cvt_pk_bf16_f32 v98, v64, v65
    v_cvt_pk_bf16_f32 v99, v66, v67
    v_cvt_pk_bf16_f32 v100, v68, v69
    v_cvt_pk_bf16_f32 v101, v70, v71
    v_cvt_pk_bf16_f32 v102, v72, v73
    v_cvt_pk_bf16_f32 v103, v74, v75
    s_add_u32 s65, s64, 4194304
    buffer_store_dwordx4 v[96:99], v25, s[36:39], s65 offen sc1
    buffer_store_dwordx4 v[100:103], v25, s[36:39], s65 offen offset:512 sc1
    v_mul_f32 v28, s66, v28
    v_mul_f32 v29, s66, v29
    v_mul_f32 v30, s66, v30
    v_mul_f32 v31, s66, v31
    v_mul_f32 v32, s66, v32
    v_mul_f32 v33, s66, v33
    v_mul_f32 v34, s66, v34
    v_mul_f32 v35, s66, v35
    v_mul_f32 v36, s66, v36
    v_mul_f32 v37, s66, v37
    v_mul_f32 v38, s66, v38
    v_mul_f32 v39, s66, v39
    v_mul_f32 v40, s66, v40
    v_mul_f32 v41, s66, v41
    v_mul_f32 v42, s66, v42
    v_mul_f32 v43, s66, v43
    v_cvt_pk_bf16_f32 v104, v28, v29
    v_cvt_pk_bf16_f32 v105, v30, v31
    v_cvt_pk_bf16_f32 v106, v32, v33
    v_cvt_pk_bf16_f32 v107, v34, v35
    v_cvt_pk_bf16_f32 v108, v36, v37
    v_cvt_pk_bf16_f32 v109, v38, v39
    v_cvt_pk_bf16_f32 v110, v40, v41
    v_cvt_pk_bf16_f32 v111, v42, v43
    s_add_u32 s65, s64, 0
    s_add_u32 s67, s64, 65536
    buffer_store_dwordx4 v[104:107], v23, s[36:39], s65 offen sc1
    buffer_store_dwordx4 v[108:111], v23, s[36:39], s67 offen sc1
    v_mov_b32 v18, s26
    v_mov_b32 v19, s27
    s_waitcnt vmcnt(0)
    s_mov_b64 exec, 1
    buffer_store_dwordx2 v[18:19], v17, s[36:39], s68 offen sc1
    s_mov_b64 exec, -1
L_epi_done_25:
    v_mov_b32 v15, 1
    s_mov_b64 exec, 1
    ds_write_b32 v16, v15
    s_mov_b64 exec, -1
L_attn:
    s_lshl_b32 s72, s57, 2
    s_bfe_u32 s73, s2, 0x20003
    s_add_u32 s72, s72, s73
    s_lshr_b32 s73, s2, 5
    s_lshl_b32 s74, s72, 16
    s_mov_b32 s86, 0x4b
    v_lshlrev_b32 v6, 4, v0
    s_lshl_b32 s75, s73, 3
    s_add_u32 s75, s75, s3
    s_setprio 3
    s_cmp_ge_u32 s3, 2
    s_cbranch_scc1 L_prio_26
    s_setprio 2
L_prio_26:
    v_mov_b32 v2, v6
    v_lshrrev_b32 v8, 5, v0
    v_lshlrev_b32 v8, 8, v8
    v_and_b32 v9, 15, v0
    v_lshl_add_u32 v8, v9, 4, v8
    v_add_u32 v8, 65536, v8
    v_add_u32 v9, 512, v8
    v_and_b32 v3, 16, v0
    v_cmp_eq_u32 vcc, 0, v3
    v_mov_b32 v4, 66560
    v_and_b32 v5, 11, v0
    v_cmp_ne_u32 s[84:85], 0, v5
    v_mov_b32 v5, 66576
    s_lshl_b32 s76, s3, 10
    v_cndmask_b32 v4, v4, v5, s[84:85]
    v_mov_b32 v5, 0xdddddddd
    v_cndmask_b32 v3, v4, v8, vcc
    v_cndmask_b32 v4, v4, v9, vcc
    s_add_u32 s76, s76, 135296
    v_add_u32 v9, s76, v6
    s_mov_b32 s82, 0
    v_mov_b32 v7, 143488
    s_mov_b32 s99, 3200000
L_lw_27:
    ds_read_b128 v[16:19], v7 offset:0
    s_waitcnt lgkmcnt(0)
    v_min3_u32 v16, v16, v17, v18
    v_min_u32 v16, v16, v19
    s_nop 0
    v_readfirstlane_b32 s98, v16
    s_nop 1
    s_cmp_ge_u32 s98, 1
    s_cbranch_scc1 L_lw_done_28
    s_sub_u32 s99, s99, 1
    s_cbranch_scc1 L_lw_done_28
    s_sleep 1
    s_branch L_lw_27
L_lw_done_28:
    ds_read_b128 v[12:15], v9
L_attn_run_29:
    ds_read_b128 v[20:23], v2
    ds_read_b128 v[28:31], v3
    ds_read_b128 v[24:27], v2 offset:1024
    ds_read_b128 v[32:35], v4
    s_waitcnt lgkmcnt(3)
    v_mfma_f32_32x32x16_bf16 v[76:91], v[20:23], v[12:15], 0
    v_mov_b32 v100, 0
    v_mov_b32 v101, 0
    v_mov_b32 v102, 0
    v_mov_b32 v103, 0
    v_mov_b32 v104, 0
    v_mov_b32 v105, 0
    v_mov_b32 v106, 0
    v_mov_b32 v107, 0
    v_mov_b32 v40, 0
    v_mov_b32 v41, 0
    v_mov_b32 v42, 0
    v_mov_b32 v43, 0
    s_cmp_lg_u32 s82, 0
    s_cbranch_scc1 L_attn_have_30
    v_max3_f32 v8, v76, v77, v78
    v_max_f32 v8, v8, v79
    v_max3_f32 v8, v8, v80, v81
    v_max3_f32 v8, v8, v82, v83
    v_max3_f32 v8, v8, v84, v85
    v_max3_f32 v8, v8, v86, v87
    v_max3_f32 v8, v8, v88, v89
    v_max3_f32 v8, v8, v90, v91
    v_add_f32 v8, 0x42bc0000, v8
L_attn_have_30:
    v_mov_b32 v9, v8
    v_mov_b32 v60, 0
    v_mov_b32 v61, 0
    v_permlane32_swap_b32 v8, v9
    v_mov_b32 v62, 0
    v_mov_b32 v63, 0
    v_max_f32 v8, v8, v9
    v_sub_f32 v76, v76, v8
    v_sub_f32 v77, v77, v8
    v_sub_f32 v78, v78, v8
    v_sub_f32 v79, v79, v8
    v_sub_f32 v80, v80, v8
    v_sub_f32 v81, v81, v8
    v_sub_f32 v82, v82, v8
    v_sub_f32 v83, v83, v8
    v_sub_f32 v84, v84, v8
    v_sub_f32 v85, v85, v8
    v_sub_f32 v86, v86, v8
    v_sub_f32 v87, v87, v8
    v_sub_f32 v88, v88, v8
    v_sub_f32 v89, v89, v8
    v_sub_f32 v90, v90, v8
    v_sub_f32 v91, v91, v8
    v_sub_f32 v44, 0, v8
    v_sub_f32 v45, 0, v8
    v_sub_f32 v46, 0, v8
    v_sub_f32 v47, 0, v8
    v_sub_f32 v48, 0, v8
    v_sub_f32 v49, 0, v8
    v_sub_f32 v50, 0, v8
    v_sub_f32 v51, 0, v8
    v_sub_f32 v52, 0, v8
    v_sub_f32 v53, 0, v8
    v_sub_f32 v54, 0, v8
    v_sub_f32 v55, 0, v8
    v_sub_f32 v56, 0, v8
    v_sub_f32 v57, 0, v8
    v_sub_f32 v58, 0, v8
    v_sub_f32 v59, 0, v8
    v_mov_b32 v64, 0
    v_mov_b32 v65, 0
    v_mov_b32 v66, 0
    v_mov_b32 v67, 0
    v_mov_b32 v68, 0
    v_mov_b32 v69, 0
    v_mov_b32 v70, 0
    v_mov_b32 v71, 0
    v_mov_b32 v72, 0
    v_mov_b32 v73, 0
    v_mov_b32 v74, 0
    v_mov_b32 v75, 0
    s_waitcnt lgkmcnt(0)
    s_mov_b32 s83, 0
.p2align 6
L_attn_loop_31:
    v_exp_f32 v76, v76
    v_exp_f32 v77, v77
    v_smfmac_f32_32x32x32_bf16 v[60:75], v[40:43], v[100:107], v5
    ds_read_b128 v[36:39], v3 offset:1056
    v_exp_f32 v78, v78
    v_exp_f32 v79, v79
    v_exp_f32 v80, v80
    s_waitcnt lgkmcnt(1)
    v_exp_f32 v81, v81
    v_mfma_f32_32x32x16_bf16 v[92:107], v[24:27], v[12:15], v[44:59]
    ds_read_b128 v[20:23], v2 offset:2048
    v_exp_f32 v82, v82
    v_exp_f32 v83, v83
    v_exp_f32 v84, v84
    v_exp_f32 v85, v85
    v_exp_f32 v86, v86
    v_smfmac_f32_32x32x32_bf16 v[60:75], v[28:31], v[76:83], v5
    ds_read_b128 v[40:43], v4 offset:1056
    v_exp_f32 v87, v87
    v_exp_f32 v88, v88
    v_exp_f32 v89, v89
    v_exp_f32 v90, v90
    v_exp_f32 v91, v91
    v_exp_f32 v92, v92
    v_exp_f32 v93, v93
    v_smfmac_f32_32x32x32_bf16 v[60:75], v[32:35], v[84:91], v5
    ds_read_b128 v[28:31], v3 offset:2112
    v_exp_f32 v94, v94
    v_exp_f32 v95, v95
    v_exp_f32 v96, v96
    s_waitcnt lgkmcnt(1)
    v_exp_f32 v97, v97
    v_mfma_f32_32x32x16_bf16 v[76:91], v[20:23], v[12:15], v[44:59]
    ds_read_b128 v[24:27], v2 offset:3072
    v_exp_f32 v98, v98
    v_exp_f32 v99, v99
    v_exp_f32 v100, v100
    v_exp_f32 v101, v101
    v_exp_f32 v102, v102
    v_smfmac_f32_32x32x32_bf16 v[60:75], v[36:39], v[92:99], v5
    ds_read_b128 v[32:35], v4 offset:2112
    v_exp_f32 v103, v103
    v_exp_f32 v104, v104
    v_exp_f32 v105, v105
    v_exp_f32 v106, v106
    v_exp_f32 v107, v107
    v_exp_f32 v76, v76
    v_exp_f32 v77, v77
    v_smfmac_f32_32x32x32_bf16 v[60:75], v[40:43], v[100:107], v5
    ds_read_b128 v[36:39], v3 offset:3168
    v_exp_f32 v78, v78
    v_exp_f32 v79, v79
    v_exp_f32 v80, v80
    s_waitcnt lgkmcnt(1)
    v_exp_f32 v81, v81
    v_mfma_f32_32x32x16_bf16 v[92:107], v[24:27], v[12:15], v[44:59]
    ds_read_b128 v[20:23], v2 offset:4096
    v_exp_f32 v82, v82
    v_exp_f32 v83, v83
    v_exp_f32 v84, v84
    v_exp_f32 v85, v85
    v_exp_f32 v86, v86
    v_smfmac_f32_32x32x32_bf16 v[60:75], v[28:31], v[76:83], v5
    ds_read_b128 v[40:43], v4 offset:3168
    v_exp_f32 v87, v87
    v_exp_f32 v88, v88
    v_exp_f32 v89, v89
    v_exp_f32 v90, v90
    v_exp_f32 v91, v91
    v_exp_f32 v92, v92
    v_exp_f32 v93, v93
    v_smfmac_f32_32x32x32_bf16 v[60:75], v[32:35], v[84:91], v5
    ds_read_b128 v[28:31], v3 offset:4224
    v_exp_f32 v94, v94
    v_exp_f32 v95, v95
    v_exp_f32 v96, v96
    s_waitcnt lgkmcnt(1)
    v_exp_f32 v97, v97
    v_mfma_f32_32x32x16_bf16 v[76:91], v[20:23], v[12:15], v[44:59]
    ds_read_b128 v[24:27], v2 offset:5120
    v_exp_f32 v98, v98
    v_exp_f32 v99, v99
    v_exp_f32 v100, v100
    v_exp_f32 v101, v101
    v_exp_f32 v102, v102
    v_smfmac_f32_32x32x32_bf16 v[60:75], v[36:39], v[92:99], v5
    ds_read_b128 v[32:35], v4 offset:4224
    v_exp_f32 v103, v103
    v_exp_f32 v104, v104
    v_exp_f32 v105, v105
    v_exp_f32 v106, v106
    v_exp_f32 v107, v107
    v_exp_f32 v76, v76
    v_exp_f32 v77, v77
    v_smfmac_f32_32x32x32_bf16 v[60:75], v[40:43], v[100:107], v5
    ds_read_b128 v[36:39], v3 offset:5280
    v_exp_f32 v78, v78
    v_exp_f32 v79, v79
    v_exp_f32 v80, v80
    s_waitcnt lgkmcnt(1)
    v_exp_f32 v81, v81
    v_mfma_f32_32x32x16_bf16 v[92:107], v[24:27], v[12:15], v[44:59]
    ds_read_b128 v[20:23], v2 offset:6144
    v_exp_f32 v82, v82
    v_exp_f32 v83, v83
    v_exp_f32 v84, v84
    v_exp_f32 v85, v85
    v_exp_f32 v86, v86
    v_smfmac_f32_32x32x32_bf16 v[60:75], v[28:31], v[76:83], v5
    ds_read_b128 v[40:43], v4 offset:5280
    v_exp_f32 v87, v87
    v_exp_f32 v88, v88
    v_exp_f32 v89, v89
    v_exp_f32 v90, v90
    v_exp_f32 v91, v91
    v_exp_f32 v92, v92
    v_exp_f32 v93, v93
    v_smfmac_f32_32x32x32_bf16 v[60:75], v[32:35], v[84:91], v5
    ds_read_b128 v[28:31], v3 offset:6336
    v_exp_f32 v94, v94
    v_exp_f32 v95, v95
    v_exp_f32 v96, v96
    s_waitcnt lgkmcnt(1)
    v_exp_f32 v97, v97
    v_mfma_f32_32x32x16_bf16 v[76:91], v[20:23], v[12:15], v[44:59]
    ds_read_b128 v[24:27], v2 offset:7168
    v_exp_f32 v98, v98
    v_exp_f32 v99, v99
    v_exp_f32 v100, v100
    v_exp_f32 v101, v101
    v_exp_f32 v102, v102
    v_smfmac_f32_32x32x32_bf16 v[60:75], v[36:39], v[92:99], v5
    ds_read_b128 v[32:35], v4 offset:6336
    v_exp_f32 v103, v103
    v_exp_f32 v104, v104
    v_exp_f32 v105, v105
    v_exp_f32 v106, v106
    v_exp_f32 v107, v107
    v_exp_f32 v76, v76
    v_exp_f32 v77, v77
    v_smfmac_f32_32x32x32_bf16 v[60:75], v[40:43], v[100:107], v5
    ds_read_b128 v[36:39], v3 offset:7392
    v_exp_f32 v78, v78
    s_bitcmp1_b32 s86, s83
    v_exp_f32 v79, v79
    s_cbranch_scc1 L_attn_event_32
L_attn_back_33:
    v_exp_f32 v80, v80
    s_waitcnt lgkmcnt(1)
    v_exp_f32 v81, v81
    v_mfma_f32_32x32x16_bf16 v[92:107], v[24:27], v[12:15], v[44:59]
    ds_read_b128 v[20:23], v2 offset:8192
    v_exp_f32 v82, v82
    v_exp_f32 v83, v83
    v_exp_f32 v84, v84
    v_exp_f32 v85, v85
    v_exp_f32 v86, v86
    v_smfmac_f32_32x32x32_bf16 v[60:75], v[28:31], v[76:83], v5
    ds_read_b128 v[40:43], v4 offset:7392
    v_exp_f32 v87, v87
    v_exp_f32 v88, v88
    v_exp_f32 v89, v89
    v_exp_f32 v90, v90
    v_exp_f32 v91, v91
    v_exp_f32 v92, v92
    v_exp_f32 v93, v93
    v_smfmac_f32_32x32x32_bf16 v[60:75], v[32:35], v[84:91], v5
    ds_read_b128 v[28:31], v3 offset:8448
    v_exp_f32 v94, v94
    v_exp_f32 v95, v95
    v_exp_f32 v96, v96
    s_waitcnt lgkmcnt(1)
    v_exp_f32 v97, v97
    v_mfma_f32_32x32x16_bf16 v[76:91], v[20:23], v[12:15], v[44:59]
    ds_read_b128 v[24:27], v2 offset:9216
    v_exp_f32 v98, v98
    v_exp_f32 v99, v99
    v_exp_f32 v100, v100
    v_exp_f32 v101, v101
    v_exp_f32 v102, v102
    v_smfmac_f32_32x32x32_bf16 v[60:75], v[36:39], v[92:99], v5
    ds_read_b128 v[32:35], v4 offset:8448
    v_exp_f32 v103, v103
    v_add_u32 v2, 8192, v2
    v_exp_f32 v104, v104
    v_add_u32 v3, 8448, v3
    s_add_u32 s83, s83, 1
    v_exp_f32 v105, v105
    v_add_u32 v4, 8448, v4
    s_cmp_lg_u32 s83, 8
    v_exp_f32 v106, v106
    v_exp_f32 v107, v107
    s_cbranch_scc1 L_attn_loop_31
    s_nop 1
    v_smfmac_f32_32x32x32_bf16 v[60:75], v[40:43], v[100:107], v5
    v_subrev_u32 v2, 65536, v2
    v_subrev_u32 v3, 67584, v3
    v_subrev_u32 v4, 67584, v4
    s_lshl_b32 s76, s75, 10
    s_add_u32 s76, s76, s74
    s_add_u32 s76, s76, 6291456
    s_lshl_b32 s77, s75, 8
    s_lshl_b32 s78, s72, 3
    s_add_u32 s77, s77, s78
    s_add_u32 s77, s77, 22036480
    s_waitcnt lgkmcnt(0)
    s_nop 5
    s_cmp_lg_u32 s82, 0
    s_cbranch_scc1 L_attn_fin_34
    v_mov_b32 v9, 0x71800000
    v_mov_b32 v8, 0x207
    v_cmp_nlt_f32 s[84:85], v68, v9
    v_max3_f32 v9, abs(v60), abs(v61), abs(v62)
    v_max3_f32 v9, v9, abs(v63), abs(v64)
    v_max3_f32 v9, v9, abs(v65), abs(v66)
    v_max3_f32 v9, v9, abs(v67), abs(v67)
    v_cmp_gt_f32 vcc, 0x0b800000, v9
    s_or_b64 s[84:85], s[84:85], vcc
    v_cmp_class_f32 vcc, v60, v8
    s_or_b64 s[84:85], s[84:85], vcc
    v_cmp_class_f32 vcc, v61, v8
    s_or_b64 s[84:85], s[84:85], vcc
    v_cmp_class_f32 vcc, v62, v8
    s_or_b64 s[84:85], s[84:85], vcc
    v_cmp_class_f32 vcc, v63, v8
    s_or_b64 s[84:85], s[84:85], vcc
    v_cmp_class_f32 vcc, v64, v8
    s_or_b64 s[84:85], s[84:85], vcc
    v_cmp_class_f32 vcc, v65, v8
    s_or_b64 s[84:85], s[84:85], vcc
    v_cmp_class_f32 vcc, v66, v8
    s_or_b64 s[84:85], s[84:85], vcc
    v_cmp_class_f32 vcc, v67, v8
    s_or_b64 s[84:85], s[84:85], vcc
    s_cmp_eq_u64 s[84:85], 0
    s_cbranch_scc0 L_attn_fallback
L_attn_fin_34:
    v_rcp_f32 v8, v68
    v_mov_b32 v9, 0
    v_mul_f32 v60, v60, v8
    v_mul_f32 v61, v61, v8
    v_mul_f32 v62, v62, v8
    v_mul_f32 v63, v63, v8
    v_mul_f32 v64, v64, v8
    v_mul_f32 v65, v65, v8
    v_mul_f32 v66, v66, v8
    v_mul_f32 v67, v67, v8
    v_cvt_pk_bf16_f32 v12, v60, v61
    v_cvt_pk_bf16_f32 v13, v62, v63
    v_cvt_pk_bf16_f32 v14, v64, v65
    v_cvt_pk_bf16_f32 v15, v66, v67
    buffer_store_dwordx4 v[12:15], v6, s[36:39], s76 offen sc1
    s_waitcnt vmcnt(0)
    v_mov_b32 v20, s26
    v_mov_b32 v21, s27
    s_mov_b64 exec, 1
    buffer_store_dwordx2 v[20:21], v9, s[36:39], s77 offen sc1
    s_mov_b64 exec, -1
L_early_flag_done_35:
    s_mov_b32 s48, s20
    s_and_b32 s49, s21, 0xffff
    s_mov_b32 s50, 0x400000
    s_mov_b32 s51, 0x20000
    s_mov_b32 s52, s8
    s_and_b32 s53, s9, 0xffff
    s_mov_b32 s54, 0x80000
    s_mov_b32 s55, 0x20000
    v_lshlrev_b32 v2, 4, v0
    v_lshlrev_b32 v4, 3, v0
    s_and_b32 s72, s2, 7
    s_lshr_b32 s73, s2, 3
    s_lshl_b32 s86, s72, 2
    s_and_b32 s87, s73, 3
    s_add_u32 s86, s86, s87
    s_lshr_b32 s87, s73, 2
    v_lshrrev_b32 v5, 2, v0
    v_lshlrev_b32 v3, 10, v5
    v_and_b32 v5, 3, v0
    v_lshl_add_u32 v3, v5, 4, v3
    s_lshr_b32 s82, s3, 1
    s_and_b32 s98, s3, 1
    s_lshl_b32 s93, s3, 16
    s_lshl_b32 s89, s87, 7
    s_add_u32 s93, s93, s89
    s_lshl_b32 s90, s3, 12
    v_lshrrev_b32 v5, 5, v0
    v_lshlrev_b32 v6, 8, v5
    v_bfe_u32 v5, v0, 2, 2
    v_lshl_add_u32 v6, v5, 6, v6
    v_bfe_u32 v5, v0, 4, 1
    v_lshl_add_u32 v6, v5, 5, v6
    v_and_b32 v5, 3, v0
    v_lshl_add_u32 v6, v5, 3, v6
    s_lshl_b32 s85, s82, 13
    v_add_u32 v10, s85, v6
    v_mov_b32 v12, 0
    v_mov_b32 v13, 0
    v_mov_b32 v14, 0
    v_mov_b32 v15, 0
    v_mov_b32 v16, 0
    v_mov_b32 v17, 0
    v_mov_b32 v18, 0
    v_mov_b32 v19, 0
    v_mov_b32 v20, 0
    v_mov_b32 v21, 0
    v_mov_b32 v22, 0
    v_mov_b32 v23, 0
    v_mov_b32 v24, 0
    v_mov_b32 v25, 0
    v_mov_b32 v26, 0
    v_mov_b32 v27, 0
    v_mov_b32 v28, 0
    v_mov_b32 v29, 0
    v_mov_b32 v30, 0
    v_mov_b32 v31, 0
    v_mov_b32 v32, 0
    v_mov_b32 v33, 0
    v_mov_b32 v34, 0
    v_mov_b32 v35, 0
    v_mov_b32 v36, 0
    v_mov_b32 v37, 0
    v_mov_b32 v38, 0
    v_mov_b32 v39, 0
    v_mov_b32 v40, 0
    v_mov_b32 v41, 0
    v_mov_b32 v42, 0
    v_mov_b32 v43, 0
    s_lshl_b32 s91, s86, 1
    s_add_u32 s91, s91, s98
    s_lshl_b32 s88, s91, 10
    s_lshl_b32 s85, s82, 19
    s_add_u32 s88, s88, s85
    s_add_u32 s88, s88, 6291456
    s_lshl_b32 s84, s91, 8
    s_lshl_b32 s85, s82, 6
    s_add_u32 s84, s84, s85
    s_add_u32 s84, s84, 22036480
    s_barrier
    s_add_u32 s94, s93, 64
    s_add_u32 m0, s90, 0
    s_nop 0
    buffer_load_dwordx4 v3, s[52:55], s93 offen lds
    s_add_u32 m0, s90, 32768
    s_nop 0
    buffer_load_dwordx4 v3, s[52:55], s94 offen lds
    s_add_u32 s93, s93, 16384
    s_add_u32 s94, s93, 64
    s_add_u32 m0, s90, 1024
    s_nop 0
    buffer_load_dwordx4 v3, s[52:55], s93 offen lds
    s_add_u32 m0, s90, 33792
    s_nop 0
    buffer_load_dwordx4 v3, s[52:55], s94 offen lds
    s_add_u32 s93, s93, 16384
    s_add_u32 s94, s93, 64
    s_add_u32 m0, s90, 2048
    s_nop 0
    buffer_load_dwordx4 v3, s[52:55], s93 offen lds
    s_add_u32 m0, s90, 34816
    s_nop 0
    buffer_load_dwordx4 v3, s[52:55], s94 offen lds
    s_add_u32 s93, s93, 16384
    s_add_u32 s94, s93, 64
    s_add_u32 m0, s90, 3072
    s_nop 0
    buffer_load_dwordx4 v3, s[52:55], s93 offen lds
    s_add_u32 m0, s90, 35840
    s_nop 0
    buffer_load_dwordx4 v3, s[52:55], s94 offen lds
    s_waitcnt vmcnt(0)
    s_barrier
    s_mov_b64 s[92:93], 0xff
    ds_read_b64_tr_b16 v[44:45], v10 offset:0
    ds_read_b64_tr_b16 v[46:47], v10 offset:512
    ds_read_b64_tr_b16 v[48:49], v10 offset:32768
    ds_read_b64_tr_b16 v[50:51], v10 offset:33280
    ds_read_b64_tr_b16 v[52:53], v10 offset:1024
    ds_read_b64_tr_b16 v[54:55], v10 offset:1536
    ds_read_b64_tr_b16 v[56:57], v10 offset:33792
    ds_read_b64_tr_b16 v[58:59], v10 offset:34304
    ds_read_b64_tr_b16 v[60:61], v10 offset:2048
    ds_read_b64_tr_b16 v[62:63], v10 offset:2560
    ds_read_b64_tr_b16 v[64:65], v10 offset:34816
    ds_read_b64_tr_b16 v[66:67], v10 offset:35328
    s_waitcnt lgkmcnt(4)
    ds_read_b64_tr_b16 v[68:69], v10 offset:3072
    ds_read_b64_tr_b16 v[70:71], v10 offset:3584
    ds_read_b64_tr_b16 v[72:73], v10 offset:35840
    ds_read_b64_tr_b16 v[74:75], v10 offset:36352
    ds_read_b64_tr_b16 v[76:77], v10 offset:4096
    ds_read_b64_tr_b16 v[78:79], v10 offset:4608
    ds_read_b64_tr_b16 v[80:81], v10 offset:36864
    ds_read_b64_tr_b16 v[82:83], v10 offset:37376
    s_waitcnt lgkmcnt(4)
    ds_read_b64_tr_b16 v[84:85], v10 offset:5120
    ds_read_b64_tr_b16 v[86:87], v10 offset:5632
    ds_read_b64_tr_b16 v[88:89], v10 offset:37888
    ds_read_b64_tr_b16 v[90:91], v10 offset:38400
    ds_read_b64_tr_b16 v[92:93], v10 offset:6144
    ds_read_b64_tr_b16 v[94:95], v10 offset:6656
    ds_read_b64_tr_b16 v[96:97], v10 offset:38912
    ds_read_b64_tr_b16 v[98:99], v10 offset:39424
    s_waitcnt lgkmcnt(4)
    ds_read_b64_tr_b16 v[100:101], v10 offset:7168
    ds_read_b64_tr_b16 v[102:103], v10 offset:7680
    ds_read_b64_tr_b16 v[104:105], v10 offset:39936
    ds_read_b64_tr_b16 v[106:107], v10 offset:40448
    s_mov_b32 s99, 400000
L_e_spoll_36:
    s_load_dwordx16 s[56:71], s[24:25], s84 glc
    s_waitcnt lgkmcnt(0)
    s_and_b64 s[92:93], s[56:57], s[58:59]
    s_or_b64 s[96:97], s[56:57], s[58:59]
    s_and_b64 s[92:93], s[92:93], s[60:61]
    s_or_b64 s[96:97], s[96:97], s[60:61]
    s_and_b64 s[92:93], s[92:93], s[62:63]
    s_or_b64 s[96:97], s[96:97], s[62:63]
    s_and_b64 s[92:93], s[92:93], s[64:65]
    s_or_b64 s[96:97], s[96:97], s[64:65]
    s_and_b64 s[92:93], s[92:93], s[66:67]
    s_or_b64 s[96:97], s[96:97], s[66:67]
    s_and_b64 s[92:93], s[92:93], s[68:69]
    s_or_b64 s[96:97], s[96:97], s[68:69]
    s_and_b64 s[92:93], s[92:93], s[70:71]
    s_or_b64 s[96:97], s[96:97], s[70:71]
    s_xor_b64 s[92:93], s[92:93], s[26:27]
    s_xor_b64 s[96:97], s[96:97], s[26:27]
    s_or_b64 s[92:93], s[92:93], s[96:97]
    s_cbranch_scc0 L_e_spoll_done_37
    s_sub_u32 s99, s99, 1
    s_cbranch_scc1 L_e_spoll_done_37
    s_sleep 1
    s_branch L_e_spoll_36
L_e_spoll_done_37:
    buffer_load_dwordx4 v[108:111], v2, s[36:39], s88 offen sc1
    s_add_u32 s88, s88, 65536
    buffer_load_dwordx4 v[112:115], v2, s[36:39], s88 offen sc1
    s_add_u32 s88, s88, 65536
    buffer_load_dwordx4 v[116:119], v2, s[36:39], s88 offen sc1
    s_add_u32 s88, s88, 65536
    buffer_load_dwordx4 v[120:123], v2, s[36:39], s88 offen sc1
    s_add_u32 s88, s88, 65536
    buffer_load_dwordx4 v[124:127], v2, s[36:39], s88 offen sc1
    s_add_u32 s88, s88, 65536
    buffer_load_dwordx4 v[128:131], v2, s[36:39], s88 offen sc1
    s_add_u32 s88, s88, 65536
    buffer_load_dwordx4 v[132:135], v2, s[36:39], s88 offen sc1
    s_add_u32 s88, s88, 65536
    buffer_load_dwordx4 v[136:139], v2, s[36:39], s88 offen sc1
    s_lshl_b32 s84, s98, 15
    s_add_u32 s84, s84, 65536
    s_lshl_b32 s85, s82, 11
    s_add_u32 s85, s85, s84
    v_add_u32 v5, s85, v2
    s_lshl_b32 s85, s82, 13
    s_add_u32 s85, s85, s84
    v_add_u32 v6, s85, v2
    v_and_b32 v3, 31, v0
    v_lshlrev_b32 v3, 11, v3
    v_lshrrev_b32 v7, 5, v0
    v_lshl_add_u32 v3, v7, 4, v3
    s_lshl_b32 s84, s91, 16
    s_lshl_b32 s85, s87, 7
    s_add_u32 s84, s84, s85
    s_lshl_b32 s85, s82, 5
    s_add_u32 s84, s84, s85
    s_waitcnt lgkmcnt(0)
    s_waitcnt vmcnt(7)
    v_mfma_f32_32x32x16_bf16 v[12:27], v[44:47], v[108:111], v[12:27]
    v_mfma_f32_32x32x16_bf16 v[28:43], v[48:51], v[108:111], v[28:43]
    s_waitcnt vmcnt(6)
    v_mfma_f32_32x32x16_bf16 v[12:27], v[52:55], v[112:115], v[12:27]
    v_mfma_f32_32x32x16_bf16 v[28:43], v[56:59], v[112:115], v[28:43]
    s_waitcnt vmcnt(5)
    v_mfma_f32_32x32x16_bf16 v[12:27], v[60:63], v[116:119], v[12:27]
    v_mfma_f32_32x32x16_bf16 v[28:43], v[64:67], v[116:119], v[28:43]
    s_waitcnt vmcnt(4)
    v_mfma_f32_32x32x16_bf16 v[12:27], v[68:71], v[120:123], v[12:27]
    v_mfma_f32_32x32x16_bf16 v[28:43], v[72:75], v[120:123], v[28:43]
    s_waitcnt vmcnt(3)
    v_mfma_f32_32x32x16_bf16 v[12:27], v[76:79], v[124:127], v[12:27]
    v_mfma_f32_32x32x16_bf16 v[28:43], v[80:83], v[124:127], v[28:43]
    s_waitcnt vmcnt(2)
    v_mfma_f32_32x32x16_bf16 v[12:27], v[84:87], v[128:131], v[12:27]
    v_mfma_f32_32x32x16_bf16 v[28:43], v[88:91], v[128:131], v[28:43]
    s_waitcnt vmcnt(1)
    v_mfma_f32_32x32x16_bf16 v[12:27], v[92:95], v[132:135], v[12:27]
    v_mfma_f32_32x32x16_bf16 v[28:43], v[96:99], v[132:135], v[28:43]
    s_waitcnt vmcnt(0)
    v_mfma_f32_32x32x16_bf16 v[12:27], v[100:103], v[136:139], v[12:27]
    v_mfma_f32_32x32x16_bf16 v[28:43], v[104:107], v[136:139], v[28:43]
    s_nop 10
    ds_write_b128 v5, v[12:15] offset:0
    ds_write_b128 v5, v[16:19] offset:1024
    ds_write_b128 v5, v[20:23] offset:8192
    ds_write_b128 v5, v[24:27] offset:9216
    ds_write_b128 v5, v[28:31] offset:16384
    ds_write_b128 v5, v[32:35] offset:17408
    ds_write_b128 v5, v[36:39] offset:24576
    ds_write_b128 v5, v[40:43] offset:25600
    s_waitcnt lgkmcnt(0)
    s_barrier
    ds_read_b128 v[44:47], v6 offset:0
    ds_read_b128 v[48:51], v6 offset:1024
    ds_read_b128 v[52:55], v6 offset:2048
    ds_read_b128 v[56:59], v6 offset:3072
    ds_read_b128 v[60:63], v6 offset:4096
    ds_read_b128 v[64:67], v6 offset:5120
    ds_read_b128 v[68:71], v6 offset:6144
    ds_read_b128 v[72:75], v6 offset:7168
    s_waitcnt lgkmcnt(4)
    v_add_f32 v44, v44, v52
    v_add_f32 v45, v45, v53
    v_add_f32 v46, v46, v54
    v_add_f32 v47, v47, v55
    v_add_f32 v48, v48, v56
    v_add_f32 v49, v49, v57
    v_add_f32 v50, v50, v58
    v_add_f32 v51, v51, v59
    s_waitcnt lgkmcnt(0)
    v_add_f32 v60, v60, v68
    v_add_f32 v61, v61, v69
    v_add_f32 v62, v62, v70
    v_add_f32 v63, v63, v71
    v_add_f32 v64, v64, v72
    v_add_f32 v65, v65, v73
    v_add_f32 v66, v66, v74
    v_add_f32 v67, v67, v75
    v_add_f32 v44, v44, v60
    v_add_f32 v45, v45, v61
    v_add_f32 v46, v46, v62
    v_add_f32 v47, v47, v63
    v_add_f32 v48, v48, v64
    v_add_f32 v49, v49, v65
    v_add_f32 v50, v50, v66
    v_add_f32 v51, v51, v67
    v_cvt_pk_bf16_f32 v52, v44, v45
    v_cvt_pk_bf16_f32 v53, v46, v47
    v_cvt_pk_bf16_f32 v54, v48, v49
    v_cvt_pk_bf16_f32 v55, v50, v51
    s_nop 1
    v_permlane32_swap_b32 v52, v54
    v_permlane32_swap_b32 v53, v55
    s_nop 1
    buffer_store_dwordx4 v[52:55], v3, s[48:51], s84 offen
    s_endpgm
L_attn_event_32:
    s_cmp_lg_u32 s83, 0
    s_cbranch_scc1 L_ev_38
    s_mov_b32 s99, 3200000
L_lw_42:
    ds_read_b128 v[16:19], v7 offset:0
    s_waitcnt lgkmcnt(0)
    v_min3_u32 v16, v16, v17, v18
    v_min_u32 v16, v16, v19
    s_nop 0
    v_readfirstlane_b32 s98, v16
    s_nop 1
    s_cmp_ge_u32 s98, 2
    s_cbranch_scc1 L_lw_done_43
    s_sub_u32 s99, s99, 1
    s_cbranch_scc1 L_lw_done_43
    s_sleep 1
    s_branch L_lw_42
L_lw_done_43:
    s_and_b32 s84, s3, 6
    s_cmp_lg_u32 s84, 4
    s_cbranch_scc1 L_attn_back_33
    v_mov_b32 v8, 0
    s_waitcnt vmcnt(0)
    v_mov_b32 v16, s26
    v_mov_b32 v17, s27
    s_mov_b64 exec, 1
    buffer_store_dwordx2 v[16:17], v8, s[36:39], s87 offen sc1
    s_mov_b64 exec, -1
    v_mov_b32 v8, s3
    v_lshl_add_u32 v8, v8, 2, v7
    v_mov_b32 v18, 1
    s_mov_b64 exec, 1
    ds_write_b32 v8, v18
    s_mov_b64 exec, -1
    s_branch L_attn_back_33
L_ev_38:
    s_cmp_lg_u32 s83, 1
    s_cbranch_scc1 L_ev_39
    s_setprio 2
    s_mov_b32 s99, 3200000
L_lw_44:
    ds_read_b128 v[16:19], v7 offset:0
    s_waitcnt lgkmcnt(0)
    v_min3_u32 v16, v16, v17, v18
    v_min_u32 v16, v16, v19
    s_nop 0
    v_readfirstlane_b32 s98, v16
    s_nop 1
    s_cmp_ge_u32 s98, 3
    s_cbranch_scc1 L_lw_done_45
    s_sub_u32 s99, s99, 1
    s_cbranch_scc1 L_lw_done_45
    s_sleep 1
    s_branch L_lw_44
L_lw_done_45:
    s_branch L_attn_back_33
L_ev_39:
    s_cmp_lg_u32 s83, 3
    s_cbranch_scc1 L_ev_41
    s_mov_b32 s99, 3200000
L_lw_46:
    ds_read_b128 v[16:19], v7 offset:0
    s_waitcnt lgkmcnt(0)
    v_min3_u32 v16, v16, v17, v18
    v_min_u32 v16, v16, v19
    s_nop 0
    v_readfirstlane_b32 s98, v16
    s_nop 1
    s_cmp_ge_u32 s98, 4
    s_cbranch_scc1 L_lw_done_47
    s_sub_u32 s99, s99, 1
    s_cbranch_scc1 L_lw_done_47
    s_sleep 1
    s_branch L_lw_46
L_lw_done_47:
    s_setprio 1
    s_branch L_attn_back_33
L_ev_41:
    s_setprio 0
    s_branch L_attn_back_33
L_attn_fallback:
    s_mov_b32 s82, 1
    s_mov_b32 s86, 0
    s_mov_b32 s83, 64
    v_mov_b32 v8, 0xff800000
    v_mov_b32 v9, v2
L_attn_maxloop_48:
    ds_read_b128 v[20:23], v9
    v_add_u32 v9, 1024, v9
    s_waitcnt lgkmcnt(0)
    v_mfma_f32_32x32x16_bf16 v[76:91], v[20:23], v[12:15], 0
    s_nop 15
    v_max3_f32 v8, v8, v76, v77
    v_max3_f32 v8, v8, v78, v79
    v_max3_f32 v8, v8, v80, v81
    v_max3_f32 v8, v8, v82, v83
    v_max3_f32 v8, v8, v84, v85
    v_max3_f32 v8, v8, v86, v87
    v_max3_f32 v8, v8, v88, v89
    v_max3_f32 v8, v8, v90, v91
    s_sub_u32 s83, s83, 1
    s_cmp_lg_u32 s83, 0
    s_cbranch_scc1 L_attn_maxloop_48
    s_branch L_attn_run_29
L_helper:
    s_waitcnt vmcnt(9)
    s_barrier
    s_waitcnt vmcnt(5)
    s_barrier
    s_mov_b64 exec, 0xffff
    ds_write_b32 v18, v14
    s_mov_b64 exec, -1
    s_waitcnt vmcnt(1)
    s_waitcnt lgkmcnt(0)
    s_barrier
    s_mov_b32 s99, 400000
    s_waitcnt vmcnt(0)
L_nonce_49:
    v_readfirstlane_b32 s26, v12
    v_readfirstlane_b32 s27, v13
    s_nop 1
    s_cmp_lg_u32 s26, 0
    s_cbranch_scc1 L_nonce_done_50
    s_sub_u32 s99, s99, 1
    s_cbranch_scc1 L_nonce_done_50
    s_sleep 1
    buffer_load_dwordx2 v[12:13], v14, s[40:43], 0 offen sc1
    s_waitcnt vmcnt(0)
    s_branch L_nonce_49
L_nonce_done_50:
    s_setprio 3
    v_mov_b32 v18, 143488
    s_cmp_lg_u32 s75, 0
    s_cbranch_scc1 L_h_wait_51
    s_mov_b32 s99, 3200000
L_lw_53:
    ds_read_b128 v[24:27], v18 offset:32
    s_waitcnt lgkmcnt(0)
    v_min3_u32 v24, v24, v25, v26
    v_min_u32 v24, v24, v27
    s_nop 0
    v_readfirstlane_b32 s98, v24
    s_nop 1
    s_cmp_ge_u32 s98, 1
    s_cbranch_scc1 L_lw_done_54
    s_sub_u32 s99, s99, 1
    s_cbranch_scc1 L_lw_done_54
    s_sleep 1
    s_branch L_lw_53
L_lw_done_54:
    s_mov_b32 s99, 400000
L_poll_55:
    buffer_load_dwordx2 v[24:25], v17, s[36:39], s82 offen offset:0 sc1
    s_waitcnt vmcnt(0)
    s_mov_b64 s[96:97], -1
    v_cmp_eq_u32 vcc, s26, v24
    s_and_b64 s[96:97], s[96:97], vcc
    v_cmp_eq_u32 vcc, s27, v25
    s_and_b64 s[96:97], s[96:97], vcc
    s_cmp_eq_u64 s[96:97], -1
    s_cbranch_scc1 L_poll_done_56
    s_sub_u32 s99, s99, 1
    s_cbranch_scc1 L_poll_done_56
    s_sleep 1
    s_branch L_poll_55
L_poll_done_56:
    v_mov_b32 v24, 1
    v_mov_b32 v25, 1
    ds_write_b64 v18, v[24:25] offset:24
    s_branch L_h_go_52
L_h_wait_51:
    s_mov_b32 s99, 3200000
L_lw_57:
    ds_read_b64 v[24:25], v18 offset:24
    s_waitcnt lgkmcnt(0)
    v_min_u32 v24, v24, v25
    s_nop 0
    v_readfirstlane_b32 s98, v24
    s_nop 1
    s_cmp_ge_u32 s98, 1
    s_cbranch_scc1 L_lw_done_58
    s_sub_u32 s99, s99, 1
    s_cbranch_scc1 L_lw_done_58
    s_sleep 1
    s_branch L_lw_57
L_lw_done_58:
L_h_go_52:
    s_add_u32 m0, s76, 135296
    s_nop 0
    buffer_load_dwordx4 v16, s[36:39], s79 offen offset:0 sc1 lds
    s_add_u32 m0, s76, 0
    s_nop 0
    buffer_load_dwordx4 v16, s[36:39], s80 offen offset:0 sc1 lds
    s_add_u32 m0, s77, 65536
    s_nop 0
    buffer_load_dwordx4 v16, s[36:39], s81 offen offset:0 sc1 lds
    s_add_u32 m0, s76, 135296
    s_nop 0
    buffer_load_dwordx4 v16, s[36:39], s79 offen offset:1024 sc1 lds
    s_add_u32 m0, s76, 0
    s_nop 0
    buffer_load_dwordx4 v16, s[36:39], s80 offen offset:1024 sc1 lds
    s_add_u32 m0, s77, 65568
    s_nop 0
    buffer_load_dwordx4 v16, s[36:39], s81 offen offset:1024 sc1 lds
    s_lshl_b32 s83, s75, 2
    s_lshl_b64 exec, 15, s83
    ds_write_b128 v19, v[32:35]
    ds_write_b128 v19, v[36:39] offset:16
    s_mov_b64 exec, -1
    s_waitcnt vmcnt(0) lgkmcnt(0)
    v_mov_b32 v20, 1
    s_mov_b64 exec, 1
    ds_write_b32 v21, v20
    s_mov_b64 exec, -1
    s_add_u32 s80, s80, 8192
    s_add_u32 s81, s81, 8192
    s_add_u32 m0, s76, 8192
    s_nop 0
    buffer_load_dwordx4 v16, s[36:39], s80 offen offset:0 sc1 lds
    s_add_u32 m0, s77, 73984
    s_nop 0
    buffer_load_dwordx4 v16, s[36:39], s81 offen offset:0 sc1 lds
    s_add_u32 m0, s76, 8192
    s_nop 0
    buffer_load_dwordx4 v16, s[36:39], s80 offen offset:1024 sc1 lds
    s_add_u32 m0, s77, 74016
    s_nop 0
    buffer_load_dwordx4 v16, s[36:39], s81 offen offset:1024 sc1 lds
    s_waitcnt vmcnt(0)
    v_mov_b32 v20, 2
    s_mov_b64 exec, 1
    ds_write_b32 v21, v20
    s_mov_b64 exec, -1
    s_mov_b32 s99, 3200000
L_lw_59:
    ds_read_b128 v[24:27], v18 offset:48
    s_waitcnt lgkmcnt(0)
    v_min3_u32 v24, v24, v25, v26
    v_min_u32 v24, v24, v27
    s_nop 0
    v_readfirstlane_b32 s98, v24
    s_nop 1
    s_cmp_ge_u32 s98, 2
    s_cbranch_scc1 L_lw_done_60
    s_sub_u32 s99, s99, 1
    s_cbranch_scc1 L_lw_done_60
    s_sleep 1
    s_branch L_lw_59
L_lw_done_60:
    s_mul_i32 s83, s75, 12
    s_add_u32 s83, s83, 16
    s_mov_b64 s[84:85], 0xfff
    s_lshl_b64 exec, s[84:85], s83
    ds_write_b128 v19, v[32:35]
    ds_write_b128 v19, v[36:39] offset:16
    s_mov_b64 exec, -1
    s_add_u32 s80, s80, 8192
    s_add_u32 s81, s81, 8192
    s_add_u32 m0, s76, 16384
    s_nop 0
    buffer_load_dwordx4 v16, s[36:39], s80 offen offset:0 sc1 lds
    s_add_u32 m0, s77, 82432
    s_nop 0
    buffer_load_dwordx4 v16, s[36:39], s81 offen offset:0 sc1 lds
    s_add_u32 m0, s76, 16384
    s_nop 0
    buffer_load_dwordx4 v16, s[36:39], s80 offen offset:1024 sc1 lds
    s_add_u32 m0, s77, 82464
    s_nop 0
    buffer_load_dwordx4 v16, s[36:39], s81 offen offset:1024 sc1 lds
    s_add_u32 s80, s80, 8192
    s_add_u32 s81, s81, 8192
    s_add_u32 m0, s76, 24576
    s_nop 0
    buffer_load_dwordx4 v16, s[36:39], s80 offen offset:0 sc1 lds
    s_add_u32 m0, s77, 90880
    s_nop 0
    buffer_load_dwordx4 v16, s[36:39], s81 offen offset:0 sc1 lds
    s_add_u32 m0, s76, 24576
    s_nop 0
    buffer_load_dwordx4 v16, s[36:39], s80 offen offset:1024 sc1 lds
    s_add_u32 m0, s77, 90912
    s_nop 0
    buffer_load_dwordx4 v16, s[36:39], s81 offen offset:1024 sc1 lds
    s_add_u32 s80, s80, 8192
    s_add_u32 s81, s81, 8192
    s_add_u32 m0, s76, 32768
    s_nop 0
    buffer_load_dwordx4 v16, s[36:39], s80 offen offset:0 sc1 lds
    s_add_u32 m0, s77, 99328
    s_nop 0
    buffer_load_dwordx4 v16, s[36:39], s81 offen offset:0 sc1 lds
    s_add_u32 m0, s76, 32768
    s_nop 0
    buffer_load_dwordx4 v16, s[36:39], s80 offen offset:1024 sc1 lds
    s_add_u32 m0, s77, 99360
    s_nop 0
    buffer_load_dwordx4 v16, s[36:39], s81 offen offset:1024 sc1 lds
    s_waitcnt vmcnt(4) lgkmcnt(0)
    v_mov_b32 v20, 3
    s_mov_b64 exec, 1
    ds_write_b32 v21, v20
    s_mov_b64 exec, -1
    s_add_u32 s80, s80, 8192
    s_add_u32 s81, s81, 8192
    s_add_u32 m0, s76, 40960
    s_nop 0
    buffer_load_dwordx4 v16, s[36:39], s80 offen offset:0 sc1 lds
    s_add_u32 m0, s77, 107776
    s_nop 0
    buffer_load_dwordx4 v16, s[36:39], s81 offen offset:0 sc1 lds
    s_add_u32 m0, s76, 40960
    s_nop 0
    buffer_load_dwordx4 v16, s[36:39], s80 offen offset:1024 sc1 lds
    s_add_u32 m0, s77, 107808
    s_nop 0
    buffer_load_dwordx4 v16, s[36:39], s81 offen offset:1024 sc1 lds
    s_add_u32 s80, s80, 8192
    s_add_u32 s81, s81, 8192
    s_add_u32 m0, s76, 49152
    s_nop 0
    buffer_load_dwordx4 v16, s[36:39], s80 offen offset:0 sc1 lds
    s_add_u32 m0, s77, 116224
    s_nop 0
    buffer_load_dwordx4 v16, s[36:39], s81 offen offset:0 sc1 lds
    s_add_u32 m0, s76, 49152
    s_nop 0
    buffer_load_dwordx4 v16, s[36:39], s80 offen offset:1024 sc1 lds
    s_add_u32 m0, s77, 116256
    s_nop 0
    buffer_load_dwordx4 v16, s[36:39], s81 offen offset:1024 sc1 lds
    s_add_u32 s80, s80, 8192
    s_add_u32 s81, s81, 8192
    s_add_u32 m0, s76, 57344
    s_nop 0
    buffer_load_dwordx4 v16, s[36:39], s80 offen offset:0 sc1 lds
    s_add_u32 m0, s77, 124672
    s_nop 0
    buffer_load_dwordx4 v16, s[36:39], s81 offen offset:0 sc1 lds
    s_add_u32 m0, s76, 57344
    s_nop 0
    buffer_load_dwordx4 v16, s[36:39], s80 offen offset:1024 sc1 lds
    s_add_u32 m0, s77, 124704
    s_nop 0
    buffer_load_dwordx4 v16, s[36:39], s81 offen offset:1024 sc1 lds
    s_waitcnt vmcnt(0) lgkmcnt(0)
    v_mov_b32 v20, 4
    s_mov_b64 exec, 1
    ds_write_b32 v21, v20
    s_mov_b64 exec, -1
    s_xor_b32 s75, s75, 2
    s_cmp_ge_u32 s75, 2
    s_cbranch_scc1 L_h_B_61
    s_and_b32 s78, s2, 3
    s_lshl_b32 s79, s78, 3
    s_bfe_u32 s80, s2, 0x30003
    s_add_u32 s79, s79, s80
    s_bfe_u32 s81, s2, 0x10002
    s_lshl_b32 s81, s81, 3
    s_lshr_b32 s82, s2, 6
    s_lshl_b32 s82, s82, 1
    s_add_u32 s81, s81, s82
    s_add_u32 s81, s81, s75
    s_lshr_b32 s85, s79, 3
    s_and_b32 s83, s79, 7
    s_lshl_b32 s83, s83, 5
    s_cmp_eq_u32 s85, 0
    s_addc_u32 s83, s83, 0
    s_cmp_eq_u32 s85, 2
    s_cselect_b32 s84, 256, 0
    s_add_u32 s83, s83, s84
    s_lshl_b32 s83, s83, 2
    s_add_u32 s84, s85, 1
    s_lshr_b32 s84, s84, 1
    s_add_u32 s83, s83, s84
    s_mov_b32 s82, s84
    s_mov_b32 s87, 22032384
    v_mov_b32 v18, 143488
    s_mov_b32 s99, 3200000
L_lw_63:
    ds_read_b64 v[24:25], v18 offset:16
    s_waitcnt lgkmcnt(0)
    v_min_u32 v24, v24, v25
    s_nop 0
    v_readfirstlane_b32 s98, v24
    s_nop 1
    s_cmp_ge_u32 s98, 1
    s_cbranch_scc1 L_lw_done_64
    s_sub_u32 s99, s99, 1
    s_cbranch_scc1 L_lw_done_64
    s_sleep 4
    s_branch L_lw_63
L_lw_done_64:
    s_mov_b32 s99, 400000
L_poll_65:
    buffer_load_dwordx2 v[24:25], v17, s[36:39], s87 offen offset:0 sc1
    buffer_load_dwordx2 v[26:27], v17, s[36:39], s87 offen offset:512 sc1
    buffer_load_dwordx2 v[28:29], v17, s[36:39], s87 offen offset:1024 sc1
    buffer_load_dwordx2 v[30:31], v17, s[36:39], s87 offen offset:1536 sc1
    buffer_load_dwordx2 v[32:33], v17, s[36:39], s87 offen offset:2048 sc1
    buffer_load_dwordx2 v[34:35], v17, s[36:39], s87 offen offset:2560 sc1
    buffer_load_dwordx2 v[36:37], v17, s[36:39], s87 offen offset:3072 sc1
    buffer_load_dwordx2 v[38:39], v17, s[36:39], s87 offen offset:3584 sc1
    s_waitcnt vmcnt(0)
    s_mov_b64 s[96:97], -1
    v_cmp_eq_u32 vcc, s26, v24
    s_and_b64 s[96:97], s[96:97], vcc
    v_cmp_eq_u32 vcc, s27, v25
    s_and_b64 s[96:97], s[96:97], vcc
    v_cmp_eq_u32 vcc, s26, v26
    s_and_b64 s[96:97], s[96:97], vcc
    v_cmp_eq_u32 vcc, s27, v27
    s_and_b64 s[96:97], s[96:97], vcc
    v_cmp_eq_u32 vcc, s26, v28
    s_and_b64 s[96:97], s[96:97], vcc
    v_cmp_eq_u32 vcc, s27, v29
    s_and_b64 s[96:97], s[96:97], vcc
    v_cmp_eq_u32 vcc, s26, v30
    s_and_b64 s[96:97], s[96:97], vcc
    v_cmp_eq_u32 vcc, s27, v31
    s_and_b64 s[96:97], s[96:97], vcc
    v_cmp_eq_u32 vcc, s26, v32
    s_and_b64 s[96:97], s[96:97], vcc
    v_cmp_eq_u32 vcc, s27, v33
    s_and_b64 s[96:97], s[96:97], vcc
    v_cmp_eq_u32 vcc, s26, v34
    s_and_b64 s[96:97], s[96:97], vcc
    v_cmp_eq_u32 vcc, s27, v35
    s_and_b64 s[96:97], s[96:97], vcc
    v_cmp_eq_u32 vcc, s26, v36
    s_and_b64 s[96:97], s[96:97], vcc
    v_cmp_eq_u32 vcc, s27, v37
    s_and_b64 s[96:97], s[96:97], vcc
    v_cmp_eq_u32 vcc, s26, v38
    s_and_b64 s[96:97], s[96:97], vcc
    v_cmp_eq_u32 vcc, s27, v39
    s_and_b64 s[96:97], s[96:97], vcc
    s_cmp_eq_u64 s[96:97], -1
    s_cbranch_scc1 L_poll_done_66
    s_sub_u32 s99, s99, 1
    s_cbranch_scc1 L_poll_done_66
    s_sleep 4
    s_branch L_poll_65
L_poll_done_66:
    s_lshl_b32 s87, s79, 7
    s_add_u32 s87, s87, 22028288
    s_mov_b64 s[90:91], 0xffff
    s_mov_b32 s99, 400000
L_poll_67:
    buffer_load_dwordx2 v[24:25], v17, s[36:39], s87 offen offset:0 sc1
    s_waitcnt vmcnt(0)
    s_mov_b64 s[96:97], s[90:91]
    v_cmp_eq_u32 vcc, s26, v24
    s_and_b64 s[96:97], s[96:97], vcc
    v_cmp_eq_u32 vcc, s27, v25
    s_and_b64 s[96:97], s[96:97], vcc
    s_cmp_eq_u64 s[96:97], s[90:91]
    s_cbranch_scc1 L_poll_done_68
    s_sub_u32 s99, s99, 1
    s_cbranch_scc1 L_poll_done_68
    s_sleep 4
    s_branch L_poll_67
L_poll_done_68:
    s_lshl_b32 s84, s79, 15
    s_add_u32 s84, s84, 13631488
    s_lshl_b32 s85, s82, 5
    s_add_u32 s85, s85, s81
    s_lshl_b32 s85, s85, 14
    s_add_u32 s85, s85, 8388608
    v_mov_b32 v40, 0
    v_mov_b32 v41, 0
    v_mov_b32 v42, 0
    v_mov_b32 v43, 0
    v_mov_b32 v44, 0
    v_mov_b32 v45, 0
    v_mov_b32 v46, 0
    v_mov_b32 v47, 0
    v_mov_b32 v48, 0
    v_mov_b32 v49, 0
    v_mov_b32 v50, 0
    v_mov_b32 v51, 0
    v_mov_b32 v52, 0
    v_mov_b32 v53, 0
    v_mov_b32 v54, 0
    v_mov_b32 v55, 0
    buffer_load_dwordx4 v[56:59], v16, s[36:39], s85 offen offset:0 sc1
    buffer_load_dwordx4 v[60:63], v16, s[36:39], s84 offen offset:0 sc1
    buffer_load_dwordx4 v[64:67], v16, s[36:39], s85 offen offset:1024 sc1
    buffer_load_dwordx4 v[68:71], v16, s[36:39], s84 offen offset:1024 sc1
    buffer_load_dwordx4 v[72:75], v16, s[36:39], s85 offen offset:2048 sc1
    buffer_load_dwordx4 v[76:79], v16, s[36:39], s84 offen offset:2048 sc1
    buffer_load_dwordx4 v[80:83], v16, s[36:39], s85 offen offset:3072 sc1
    buffer_load_dwordx4 v[84:87], v16, s[36:39], s84 offen offset:3072 sc1
    s_add_u32 s84, s84, 4096
    s_add_u32 s85, s85, 4096
    buffer_load_dwordx4 v[88:91], v16, s[36:39], s85 offen offset:0 sc1
    buffer_load_dwordx4 v[92:95], v16, s[36:39], s84 offen offset:0 sc1
    buffer_load_dwordx4 v[96:99], v16, s[36:39], s85 offen offset:1024 sc1
    buffer_load_dwordx4 v[100:103], v16, s[36:39], s84 offen offset:1024 sc1
    buffer_load_dwordx4 v[104:107], v16, s[36:39], s85 offen offset:2048 sc1
    buffer_load_dwordx4 v[108:111], v16, s[36:39], s84 offen offset:2048 sc1
    buffer_load_dwordx4 v[112:115], v16, s[36:39], s85 offen offset:3072 sc1
    buffer_load_dwordx4 v[116:119], v16, s[36:39], s84 offen offset:3072 sc1
    s_waitcnt vmcnt(14)
    v_mfma_f32_32x32x16_bf16 v[40:55], v[56:59], v[60:63], v[40:55]
    s_add_u32 s84, s84, 4096
    s_add_u32 s85, s85, 4096
    buffer_load_dwordx4 v[56:59], v16, s[36:39], s85 offen offset:0 sc1
    buffer_load_dwordx4 v[60:63], v16, s[36:39], s84 offen offset:0 sc1
    s_waitcnt vmcnt(14)
    v_mfma_f32_32x32x16_bf16 v[40:55], v[64:67], v[68:71], v[40:55]
    buffer_load_dwordx4 v[64:67], v16, s[36:39], s85 offen offset:1024 sc1
    buffer_load_dwordx4 v[68:71], v16, s[36:39], s84 offen offset:1024 sc1
    s_waitcnt vmcnt(14)
    v_mfma_f32_32x32x16_bf16 v[40:55], v[72:75], v[76:79], v[40:55]
    buffer_load_dwordx4 v[72:75], v16, s[36:39], s85 offen offset:2048 sc1
    buffer_load_dwordx4 v[76:79], v16, s[36:39], s84 offen offset:2048 sc1
    s_waitcnt vmcnt(14)
    v_mfma_f32_32x32x16_bf16 v[40:55], v[80:83], v[84:87], v[40:55]
    buffer_load_dwordx4 v[80:83], v16, s[36:39], s85 offen offset:3072 sc1
    buffer_load_dwordx4 v[84:87], v16, s[36:39], s84 offen offset:3072 sc1
    s_waitcnt vmcnt(14)
    v_mfma_f32_32x32x16_bf16 v[40:55], v[88:91], v[92:95], v[40:55]
    s_add_u32 s84, s84, 4096
    s_add_u32 s85, s85, 4096
    buffer_load_dwordx4 v[88:91], v16, s[36:39], s85 offen offset:0 sc1
    buffer_load_dwordx4 v[92:95], v16, s[36:39], s84 offen offset:0 sc1
    s_waitcnt vmcnt(14)
    v_mfma_f32_32x32x16_bf16 v[40:55], v[96:99], v[100:103], v[40:55]
    buffer_load_dwordx4 v[96:99], v16, s[36:39], s85 offen offset:1024 sc1
    buffer_load_dwordx4 v[100:103], v16, s[36:39], s84 offen offset:1024 sc1
    s_waitcnt vmcnt(14)
    v_mfma_f32_32x32x16_bf16 v[40:55], v[104:107], v[108:111], v[40:55]
    buffer_load_dwordx4 v[104:107], v16, s[36:39], s85 offen offset:2048 sc1
    buffer_load_dwordx4 v[108:111], v16, s[36:39], s84 offen offset:2048 sc1
    s_waitcnt vmcnt(14)
    v_mfma_f32_32x32x16_bf16 v[40:55], v[112:115], v[116:119], v[40:55]
    buffer_load_dwordx4 v[112:115], v16, s[36:39], s85 offen offset:3072 sc1
    buffer_load_dwordx4 v[116:119], v16, s[36:39], s84 offen offset:3072 sc1
    s_waitcnt vmcnt(14)
    v_mfma_f32_32x32x16_bf16 v[40:55], v[56:59], v[60:63], v[40:55]
    s_add_u32 s84, s84, 4096
    s_add_u32 s85, s85, 249856
    buffer_load_dwordx4 v[56:59], v16, s[36:39], s85 offen offset:0 sc1
    buffer_load_dwordx4 v[60:63], v16, s[36:39], s84 offen offset:0 sc1
    s_waitcnt vmcnt(14)
    v_mfma_f32_32x32x16_bf16 v[40:55], v[64:67], v[68:71], v[40:55]
    buffer_load_dwordx4 v[64:67], v16, s[36:39], s85 offen offset:1024 sc1
    buffer_load_dwordx4 v[68:71], v16, s[36:39], s84 offen offset:1024 sc1
    s_waitcnt vmcnt(14)
    v_mfma_f32_32x32x16_bf16 v[40:55], v[72:75], v[76:79], v[40:55]
    buffer_load_dwordx4 v[72:75], v16, s[36:39], s85 offen offset:2048 sc1
    buffer_load_dwordx4 v[76:79], v16, s[36:39], s84 offen offset:2048 sc1
    s_waitcnt vmcnt(14)
    v_mfma_f32_32x32x16_bf16 v[40:55], v[80:83], v[84:87], v[40:55]
    buffer_load_dwordx4 v[80:83], v16, s[36:39], s85 offen offset:3072 sc1
    buffer_load_dwordx4 v[84:87], v16, s[36:39], s84 offen offset:3072 sc1
    s_waitcnt vmcnt(14)
    v_mfma_f32_32x32x16_bf16 v[40:55], v[88:91], v[92:95], v[40:55]
    s_add_u32 s84, s84, 4096
    s_add_u32 s85, s85, 4096
    buffer_load_dwordx4 v[88:91], v16, s[36:39], s85 offen offset:0 sc1
    buffer_load_dwordx4 v[92:95], v16, s[36:39], s84 offen offset:0 sc1
    s_waitcnt vmcnt(14)
    v_mfma_f32_32x32x16_bf16 v[40:55], v[96:99], v[100:103], v[40:55]
    buffer_load_dwordx4 v[96:99], v16, s[36:39], s85 offen offset:1024 sc1
    buffer_load_dwordx4 v[100:103], v16, s[36:39], s84 offen offset:1024 sc1
    s_waitcnt vmcnt(14)
    v_mfma_f32_32x32x16_bf16 v[40:55], v[104:107], v[108:111], v[40:55]
    buffer_load_dwordx4 v[104:107], v16, s[36:39], s85 offen offset:2048 sc1
    buffer_load_dwordx4 v[108:111], v16, s[36:39], s84 offen offset:2048 sc1
    s_waitcnt vmcnt(14)
    v_mfma_f32_32x32x16_bf16 v[40:55], v[112:115], v[116:119], v[40:55]
    buffer_load_dwordx4 v[112:115], v16, s[36:39], s85 offen offset:3072 sc1
    buffer_load_dwordx4 v[116:119], v16, s[36:39], s84 offen offset:3072 sc1
    s_waitcnt vmcnt(14)
    v_mfma_f32_32x32x16_bf16 v[40:55], v[56:59], v[60:63], v[40:55]
    s_add_u32 s84, s84, 4096
    s_add_u32 s85, s85, 4096
    buffer_load_dwordx4 v[56:59], v16, s[36:39], s85 offen offset:0 sc1
    buffer_load_dwordx4 v[60:63], v16, s[36:39], s84 offen offset:0 sc1
    s_waitcnt vmcnt(14)
    v_mfma_f32_32x32x16_bf16 v[40:55], v[64:67], v[68:71], v[40:55]
    buffer_load_dwordx4 v[64:67], v16, s[36:39], s85 offen offset:1024 sc1
    buffer_load_dwordx4 v[68:71], v16, s[36:39], s84 offen offset:1024 sc1
    s_waitcnt vmcnt(14)
    v_mfma_f32_32x32x16_bf16 v[40:55], v[72:75], v[76:79], v[40:55]
    buffer_load_dwordx4 v[72:75], v16, s[36:39], s85 offen offset:2048 sc1
    buffer_load_dwordx4 v[76:79], v16, s[36:39], s84 offen offset:2048 sc1
    s_waitcnt vmcnt(14)
    v_mfma_f32_32x32x16_bf16 v[40:55], v[80:83], v[84:87], v[40:55]
    buffer_load_dwordx4 v[80:83], v16, s[36:39], s85 offen offset:3072 sc1
    buffer_load_dwordx4 v[84:87], v16, s[36:39], s84 offen offset:3072 sc1
    s_waitcnt vmcnt(14)
    v_mfma_f32_32x32x16_bf16 v[40:55], v[88:91], v[92:95], v[40:55]
    s_add_u32 s84, s84, 4096
    s_add_u32 s85, s85, 4096
    buffer_load_dwordx4 v[88:91], v16, s[36:39], s85 offen offset:0 sc1
    buffer_load_dwordx4 v[92:95], v16, s[36:39], s84 offen offset:0 sc1
    s_waitcnt vmcnt(14)
    v_mfma_f32_32x32x16_bf16 v[40:55], v[96:99], v[100:103], v[40:55]
    buffer_load_dwordx4 v[96:99], v16, s[36:39], s85 offen offset:1024 sc1
    buffer_load_dwordx4 v[100:103], v16, s[36:39], s84 offen offset:1024 sc1
    s_waitcnt vmcnt(14)
    v_mfma_f32_32x32x16_bf16 v[40:55], v[104:107], v[108:111], v[40:55]
    buffer_load_dwordx4 v[104:107], v16, s[36:39], s85 offen offset:2048 sc1
    buffer_load_dwordx4 v[108:111], v16, s[36:39], s84 offen offset:2048 sc1
    s_waitcnt vmcnt(14)
    v_mfma_f32_32x32x16_bf16 v[40:55], v[112:115], v[116:119], v[40:55]
    buffer_load_dwordx4 v[112:115], v16, s[36:39], s85 offen offset:3072 sc1
    buffer_load_dwordx4 v[116:119], v16, s[36:39], s84 offen offset:3072 sc1
    s_waitcnt vmcnt(14)
    v_mfma_f32_32x32x16_bf16 v[40:55], v[56:59], v[60:63], v[40:55]
    s_waitcnt vmcnt(12)
    v_mfma_f32_32x32x16_bf16 v[40:55], v[64:67], v[68:71], v[40:55]
    s_waitcnt vmcnt(10)
    v_mfma_f32_32x32x16_bf16 v[40:55], v[72:75], v[76:79], v[40:55]
    s_waitcnt vmcnt(8)
    v_mfma_f32_32x32x16_bf16 v[40:55], v[80:83], v[84:87], v[40:55]
    s_waitcnt vmcnt(6)
    v_mfma_f32_32x32x16_bf16 v[40:55], v[88:91], v[92:95], v[40:55]
    s_waitcnt vmcnt(4)
    v_mfma_f32_32x32x16_bf16 v[40:55], v[96:99], v[100:103], v[40:55]
    s_waitcnt vmcnt(2)
    v_mfma_f32_32x32x16_bf16 v[40:55], v[104:107], v[108:111], v[40:55]
    s_waitcnt vmcnt(0)
    v_mfma_f32_32x32x16_bf16 v[40:55], v[112:115], v[116:119], v[40:55]
    v_and_b32 v18, 31, v0
    v_lshl_add_u32 v18, v18, 2, s83
    v_lshrrev_b32 v19, 5, v0
    s_lshl_b32 s84, s81, 5
    v_lshl_add_u32 v58, v19, 2, s84
    v_lshlrev_b32 v56, 11, v18
    v_lshl_add_u32 v56, v19, 4, v56
    v_sub_u32 v20, 2048, v18
    v_lshlrev_b32 v57, 11, v20
    v_mov_b32 v20, 1024
    v_cmp_ne_u32 s[88:89], v20, v18
    s_lshl_b32 s84, s81, 6
    s_nop 4
    v_cvt_pk_bf16_f32 v64, v40, v41
    v_cvt_pk_bf16_f32 v65, v42, v43
    v_cvt_pk_bf16_f32 v66, v44, v45
    v_cvt_pk_bf16_f32 v67, v46, v47
    v_cvt_pk_bf16_f32 v68, v48, v49
    v_cvt_pk_bf16_f32 v69, v50, v51
    v_cvt_pk_bf16_f32 v70, v52, v53
    v_cvt_pk_bf16_f32 v71, v54, v55
    s_cmp_eq_u32 s81, 0
    s_cbranch_scc1 L_d_slowmir_69
    v_cvt_pk_bf16_f32 v80, v47, v46
    v_cvt_pk_bf16_f32 v81, v45, v44
    v_cvt_pk_bf16_f32 v82, v43, v42
    v_cvt_pk_bf16_f32 v83, v41, v40
    v_cvt_pk_bf16_f32 v84, v55, v54
    v_cvt_pk_bf16_f32 v85, v53, v52
    v_cvt_pk_bf16_f32 v86, v51, v50
    v_cvt_pk_bf16_f32 v87, v49, v48
    v_lshlrev_b32 v20, 4, v19
    v_sub_u32 v20, v57, v20
    s_sub_u32 s85, 2002, s84
    v_permlane32_swap_b32 v82, v80
    v_permlane32_swap_b32 v83, v81
    v_permlane32_swap_b32 v86, v84
    v_permlane32_swap_b32 v87, v85
    s_mov_b64 exec, s[88:89]
    buffer_store_dwordx4 v[80:83], v20, s[48:51], s85 offen offset:32 sc1
    buffer_store_dwordx4 v[84:87], v20, s[48:51], s85 offen sc1
    s_mov_b64 exec, -1
    s_branch L_d_mirdone_70
L_d_slowmir_69:
    s_mov_b64 exec, s[88:89]
    v_sub_u32 v80, 512, v58
    v_and_b32 v80, 511, v80
    v_lshl_add_u32 v80, v80, 1, v57
    buffer_store_short v64, v80, s[48:51], 0 offen offset:1024
    v_sub_u32 v81, 511, v58
    v_and_b32 v81, 511, v81
    v_lshl_add_u32 v81, v81, 1, v57
    buffer_store_short_d16_hi v64, v81, s[48:51], 0 offen offset:1024
    v_sub_u32 v82, 510, v58
    v_and_b32 v82, 511, v82
    v_lshl_add_u32 v82, v82, 1, v57
    buffer_store_short v65, v82, s[48:51], 0 offen offset:1024
    v_sub_u32 v83, 509, v58
    v_and_b32 v83, 511, v83
    v_lshl_add_u32 v83, v83, 1, v57
    buffer_store_short_d16_hi v65, v83, s[48:51], 0 offen offset:1024
    v_sub_u32 v88, 504, v58
    v_and_b32 v88, 511, v88
    v_lshl_add_u32 v88, v88, 1, v57
    buffer_store_short v66, v88, s[48:51], 0 offen offset:1024
    v_sub_u32 v89, 503, v58
    v_and_b32 v89, 511, v89
    v_lshl_add_u32 v89, v89, 1, v57
    buffer_store_short_d16_hi v66, v89, s[48:51], 0 offen offset:1024
    v_sub_u32 v90, 502, v58
    v_and_b32 v90, 511, v90
    v_lshl_add_u32 v90, v90, 1, v57
    buffer_store_short v67, v90, s[48:51], 0 offen offset:1024
    v_sub_u32 v91, 501, v58
    v_and_b32 v91, 511, v91
    v_lshl_add_u32 v91, v91, 1, v57
    buffer_store_short_d16_hi v67, v91, s[48:51], 0 offen offset:1024
    v_sub_u32 v96, 496, v58
    v_and_b32 v96, 511, v96
    v_lshl_add_u32 v96, v96, 1, v57
    buffer_store_short v68, v96, s[48:51], 0 offen offset:1024
    v_sub_u32 v97, 495, v58
    v_and_b32 v97, 511, v97
    v_lshl_add_u32 v97, v97, 1, v57
    buffer_store_short_d16_hi v68, v97, s[48:51], 0 offen offset:1024
    v_sub_u32 v98, 494, v58
    v_and_b32 v98, 511, v98
    v_lshl_add_u32 v98, v98, 1, v57
    buffer_store_short v69, v98, s[48:51], 0 offen offset:1024
    v_sub_u32 v99, 493, v58
    v_and_b32 v99, 511, v99
    v_lshl_add_u32 v99, v99, 1, v57
    buffer_store_short_d16_hi v69, v99, s[48:51], 0 offen offset:1024
    v_sub_u32 v104, 488, v58
    v_and_b32 v104, 511, v104
    v_lshl_add_u32 v104, v104, 1, v57
    buffer_store_short v70, v104, s[48:51], 0 offen offset:1024
    v_sub_u32 v105, 487, v58
    v_and_b32 v105, 511, v105
    v_lshl_add_u32 v105, v105, 1, v57
    buffer_store_short_d16_hi v70, v105, s[48:51], 0 offen offset:1024
    v_sub_u32 v106, 486, v58
    v_and_b32 v106, 511, v106
    v_lshl_add_u32 v106, v106, 1, v57
    buffer_store_short v71, v106, s[48:51], 0 offen offset:1024
    v_sub_u32 v107, 485, v58
    v_and_b32 v107, 511, v107
    v_lshl_add_u32 v107, v107, 1, v57
    buffer_store_short_d16_hi v71, v107, s[48:51], 0 offen offset:1024
    s_mov_b64 exec, -1
L_d_mirdone_70:
    v_mov_b32 v72, v64
    v_mov_b32 v73, v65
    v_mov_b32 v74, v66
    v_mov_b32 v75, v67
    v_mov_b32 v76, v68
    v_mov_b32 v77, v69
    v_mov_b32 v78, v70
    v_mov_b32 v79, v71
    s_nop 1
    v_permlane32_swap_b32 v72, v74
    v_permlane32_swap_b32 v73, v75
    v_permlane32_swap_b32 v76, v78
    v_permlane32_swap_b32 v77, v79
    s_nop 1
    buffer_store_dwordx4 v[72:75], v56, s[48:51], s84 offen offset:1024 sc1
    buffer_store_dwordx4 v[76:79], v56, s[48:51], s84 offen offset:1056 sc1
    s_cmp_lg_u32 s79, 0
    s_cbranch_scc1 L_h_end_62
    v_and_b32 v18, 7, v0
    v_lshlrev_b32 v18, 4, v18
    v_lshrrev_b32 v19, 3, v0
    v_lshl_add_u32 v18, v19, 13, v18
    s_lshl_b32 s85, s81, 7
    s_add_u32 s85, s85, 12582912
    s_add_u32 s86, s85, 4096
    buffer_load_dwordx4 v[40:43], v18, s[36:39], s85 offen offset:0 sc1
    buffer_load_dwordx4 v[44:47], v18, s[36:39], s85 offen offset:2048 sc1
    buffer_load_dwordx4 v[48:51], v18, s[36:39], s86 offen offset:0 sc1
    buffer_load_dwordx4 v[52:55], v18, s[36:39], s86 offen offset:2048 sc1
    s_waitcnt vmcnt(0)
    v_add_f32 v40, v40, v44
    v_add_f32 v41, v41, v45
    v_add_f32 v42, v42, v46
    v_add_f32 v43, v43, v47
    v_add_f32 v40, v40, v48
    v_add_f32 v41, v41, v49
    v_add_f32 v42, v42, v50
    v_add_f32 v43, v43, v51
    v_add_f32 v40, v40, v52
    v_add_f32 v41, v41, v53
    v_add_f32 v42, v42, v54
    v_add_f32 v43, v43, v55
    v_mov_b32 v44, v40
    v_mov_b32 v45, v41
    v_mov_b32 v46, v42
    v_mov_b32 v47, v43
    s_nop 1
    v_permlane32_swap_b32 v40, v44
    v_permlane32_swap_b32 v41, v45
    v_permlane32_swap_b32 v42, v46
    v_permlane32_swap_b32 v43, v47
    s_nop 1
    v_add_f32 v40, v40, v44
    v_add_f32 v41, v41, v45
    v_add_f32 v42, v42, v46
    v_add_f32 v43, v43, v47
    v_mov_b32 v44, v40
    v_mov_b32 v45, v41
    v_mov_b32 v46, v42
    v_mov_b32 v47, v43
    s_nop 1
    v_permlane16_swap_b32 v40, v44
    v_permlane16_swap_b32 v41, v45
    v_permlane16_swap_b32 v42, v46
    v_permlane16_swap_b32 v43, v47
    s_nop 1
    v_add_f32 v40, v40, v44
    v_add_f32 v41, v41, v45
    v_add_f32 v42, v42, v46
    v_add_f32 v43, v43, v47
    s_nop 1
    v_add_f32_dpp v40, v40, v40 row_shl:8 row_mask:0xf bank_mask:0xf bound_ctrl:0
    v_add_f32_dpp v41, v41, v41 row_shl:8 row_mask:0xf bank_mask:0xf bound_ctrl:0
    v_add_f32_dpp v42, v42, v42 row_shl:8 row_mask:0xf bank_mask:0xf bound_ctrl:0
    v_add_f32_dpp v43, v43, v43 row_shl:8 row_mask:0xf bank_mask:0xf bound_ctrl:0
    v_cvt_pk_bf16_f32 v48, v40, v41
    v_cvt_pk_bf16_f32 v49, v42, v43
    s_mov_b64 exec, 0xff
    buffer_store_dwordx2 v[48:49], v17, s[48:51], s84 offen offset:1024 sc1
    s_mov_b64 exec, -1
    s_branch L_h_end_62
L_h_B_61:
    s_lshr_b32 s76, s2, 3
    s_lshr_b32 s79, s76, 3
    s_and_b32 s77, s76, 7
    s_lshl_b32 s77, s77, 5
    s_cmp_eq_u32 s79, 0
    s_addc_u32 s77, s77, 0
    s_cmp_eq_u32 s79, 2
    s_cselect_b32 s78, 256, 0
    s_add_u32 s77, s77, s78
    s_lshl_b32 s77, s77, 2
    s_add_u32 s78, s79, 1
    s_lshr_b32 s78, s78, 1
    s_add_u32 s77, s77, s78
    s_mov_b32 s86, s78
    s_lshl_b32 s77, s77, 12
    s_and_b32 s78, s2, 3
    s_lshl_b32 s78, s78, 7
    s_sub_u32 s79, s75, 2
    s_lshl_b32 s80, s79, 6
    s_add_u32 s78, s78, s80
    s_add_u32 s78, s78, s77
    s_bitcmp0_b32 s2, 2
    s_cselect_b32 s44, s12, s14
    s_cselect_b32 s45, s13, s15
    s_and_b32 s45, s45, 0xffff
    s_mov_b32 s46, 0x800000
    s_mov_b32 s47, 0x20000
    v_and_b32 v18, 31, v0
    v_lshlrev_b32 v20, 14, v18
    v_lshrrev_b32 v19, 5, v0
    v_lshl_add_u32 v18, v19, 4, v20
    buffer_load_dwordx4 v[40:43], v18, s[44:47], s78 offen offset:0
    buffer_load_dwordx4 v[44:47], v18, s[44:47], s78 offen offset:32
    s_and_b32 s80, s2, 7
    s_lshl_b32 s80, s80, 1
    s_add_u32 s80, s80, s79
    s_cmp_lg_u32 s80, 8
    s_cbranch_scc1 L_rl_nosub_71
    s_cmp_lg_u32 s86, 2
    s_cselect_b32 s44, s12, s14
    s_cselect_b32 s45, s13, s15
    s_and_b32 s45, s45, 0xffff
    s_mov_b32 s46, 0x800000
    s_mov_b32 s47, 0x20000
    buffer_load_ushort v48, v20, s[44:47], s77 offen offset:512
    s_mov_b32 s80, 0xffff
    s_waitcnt vmcnt(0)
    s_mov_b32 exec_hi, 0
    v_bfi_b32 v40, s80, v48, v40
    s_mov_b64 exec, -1
L_rl_nosub_71:
    s_lshl_b32 s77, s2, 12
    s_lshl_b32 s78, s79, 11
    s_add_u32 s77, s77, s78
    s_add_u32 s77, s77, 13631488
    s_lshl_b32 s85, s2, 4
    s_lshl_b32 s78, s79, 3
    s_add_u32 s85, s85, s78
    s_add_u32 s85, s85, 22028288
    s_waitcnt vmcnt(0)
    buffer_store_dwordx4 v[40:43], v16, s[36:39], s77 offen offset:0 sc1
    buffer_store_dwordx4 v[44:47], v16, s[36:39], s77 offen offset:1024 sc1
    s_waitcnt vmcnt(0)
    v_mov_b32 v24, s26
    v_mov_b32 v25, s27
    s_mov_b64 exec, 1
    buffer_store_dwordx2 v[24:25], v14, s[36:39], s85 offen sc1
    s_mov_b64 exec, -1
    s_lshr_b32 s76, s2, 3
    s_or_b32 s76, s76, s79
    s_cmp_lg_u32 s76, 0
    s_cbranch_scc1 L_wb_skip_72
    buffer_wbl2 sc1
L_wb_skip_72:
    s_lshr_b32 s76, s2, 3
    s_lshl_b32 s76, s76, 1
    s_add_u32 s76, s76, s79
    s_lshl_b32 s76, s76, 13
    s_add_u32 s77, s76, 4096
    buffer_load_dwordx4 v[40:43], v16, s[52:55], s76 offen offset:0
    buffer_load_dwordx4 v[44:47], v16, s[52:55], s76 offen offset:1024
    buffer_load_dwordx4 v[48:51], v16, s[52:55], s76 offen offset:2048
    buffer_load_dwordx4 v[52:55], v16, s[52:55], s76 offen offset:3072
    buffer_load_dwordx4 v[56:59], v16, s[52:55], s77 offen offset:0
    buffer_load_dwordx4 v[60:63], v16, s[52:55], s77 offen offset:1024
    buffer_load_dwordx4 v[64:67], v16, s[52:55], s77 offen offset:2048
    buffer_load_dwordx4 v[68:71], v16, s[52:55], s77 offen offset:3072
L_h_end_62:
L_exit:
    s_endpgm
.section .rodata,"a"
.p2align 6
.amdhsa_kernel concat_heads__mha_block__spectral_fnet__prompt_kernel
  .amdhsa_next_free_vgpr 168
  .amdhsa_next_free_sgpr 102
  .amdhsa_accum_offset 168
  .amdhsa_group_segment_fixed_size 0
  .amdhsa_kernarg_size 88
  .amdhsa_user_sgpr_count 2
  .amdhsa_user_sgpr_kernarg_segment_ptr 1
  .amdhsa_system_sgpr_workgroup_id_x 1
.end_amdhsa_kernel
```
